```python
import torch

def _softmax(x, axis=-1):
    return torch.softmax(x, dim=axis)

def _gelu(x):
    return torch.nn.functional.gelu(x, approximate='tanh')

def _silu(x):
    return torch.nn.functional.silu(x)

def _sigmoid(x):
    return torch.sigmoid(x)

def _layernorm(x, axis=-1, eps=1e-05):
    m = x.mean(dim=axis, keepdim=True)
    v = x.var(dim=axis, keepdim=True, unbiased=False)
    return (x - m) / torch.sqrt(v + eps)

def _scatter_add(tgt, idx, src, axis=0):
    return tgt.clone().index_add_(axis, idx, src)

def _segment_sum(src, seg, n):
    out = torch.zeros((n,) + src.shape[1:], dtype=src.dtype)
    return out.index_add_(0, seg, src)

def _pad(x, pw):
    flat = tuple((v for pair in reversed(pw) for v in pair))
    return torch.nn.functional.pad(x, flat)
kernel_name = 'standalone__varlen_attn_packed__ragged'

def setup_inputs():

    _w = lambda a: (lambda t: t.to(torch.bfloat16) if t.is_floating_point() else t)(torch.as_tensor(a))
    cu = torch.tensor([0, 205, 520, 906, 1211, 1583, 1912, 2114, 2429, 2893, 2977, 3099, 3593, 3692, 4133, 4346, 4464], dtype=torch.int64)
    T, H, D = (int(cu[-1]), 16, 128)
    return {'q': _w((lambda *s: torch.randn(*s, dtype=torch.bfloat16) * 0.8)(T, H, D)), 'k': _w((lambda *s: torch.randn(*s, dtype=torch.bfloat16) * 0.8)(T, H, D)), 'v': _w((lambda *s: torch.randn(*s, dtype=torch.bfloat16) * 0.05)(T, H, D)), 'cu': _w(cu)}

def reference(q, k, v, cu):
    T, H, D = q.shape
    out = torch.zeros_like(q)
    scale = D ** (-0.5)
    outs = []
    for i in range(len(cu) - 1):
        s, e = (int(cu[i]), int(cu[i + 1]))
        qi, ki, vi = (q[s:e].clone(), k[s:e].clone(), v[s:e].clone())
        p = _softmax(torch.einsum('qhd,khd->hqk', qi, ki) * scale, axis=-1)
        outs.append(torch.einsum('hqk,khd->qhd', p, vi))
    return torch.concatenate(outs, axis=0)
```

```asm
; @launch grid=(256,1,1) block=(256,1,1) lds=163840
.amdgcn_target "amdgcn-amd-amdhsa--gfx950"
.text
.globl standalone__varlen_attn_packed__ragged_kernel
.p2align 12
.p2align 8
.type standalone__varlen_attn_packed__ragged_kernel,@function
standalone__varlen_attn_packed__ragged_kernel:
    s_cmp_ge_u32 s2, 256
    s_cbranch_scc1 L_end
    s_load_dwordx2 s[12:13], s[0:1], 0
    s_load_dwordx2 s[16:17], s[0:1], 8
    s_load_dwordx2 s[20:21], s[0:1], 16
    s_load_dwordx2 s[24:25], s[0:1], 32
    s_getpc_b64 s[54:55]
L_pc:
    s_lshr_b32 s58, s2, 3
    s_and_b32 s57, s2, 1
    s_lshl1_add_u32 s56, s58, s57
    s_lshl2_add_u32 s56, s56, L_mini-L_pc
    s_load_dword s62, s[54:55], s56
    s_lshl_b32 s90, s2, 6
    s_add_u32 s57, s90, L_table-L_pc
    v_mov_b32 v221, v0
    s_lshl_b32 s58, s58, 11
    v_lshl_add_u32 v1, v0, 3, s58
    v_min_u32 v1, L_table-L_pc, v1
    global_load_dword v253, v1, s[54:55]
    v_lshrrev_b32 v240, 6, v0
    v_and_b32 v241, 15, v0
    v_readfirstlane_b32 s28, v240
    v_lshrrev_b32 v242, 4, v0
    v_and_b32 v243, 3, v242
    v_lshlrev_b32 v222, 2, v243
    v_xor_b32 v244, v222, v241
    v_lshlrev_b32 v244, 4, v244
    v_lshl_add_u32 v216, v243, 12, v244
    v_xor_b32 v244, v242, v241
    v_lshlrev_b32 v244, 4, v244
    v_lshl_add_u32 v214, v242, 12, v244
    v_add_u32 v215, 64512, v214
    s_lshl_b32 s29, s28, 11
    s_mul_i32 s30, s28, 20480
    s_add_u32 s30, s30, 81920
    s_add_u32 s37, s30, 16896
    s_mov_b32 s15, 0x20000
    s_mov_b32 s19, 0x20000
    s_mov_b32 s23, 0x20000
    s_mov_b32 s27, 0x20000
    s_add_u32 m0, s29, 24576
    v_and_b32 v244, 7, v242
    v_lshlrev_b32 v244, 1, v244
    v_xor_b32 v244, v244, v241
    v_lshlrev_b32 v244, 4, v244
    v_lshl_add_u32 v212, v242, 12, v244
    v_add_u32 v213, 64512, v212
    s_waitcnt lgkmcnt(0)
    s_load_dwordx16 s[64:79], s[54:55], s57
    s_bfe_u32 s58, s62, 131100
    s_lshl1_add_u32 s58, s2, s58
    s_and_b32 s58, s58, 15
    s_and_b32 s59, s62, 0x1fff
    s_lshl4_add_u32 s58, s59, s58
    s_lshl_b32 s32, s58, 8
    s_bfe_u32 s59, s62, 327693
    s_lshl4_add_u32 s58, s59, s58
    s_add_u32 s58, s58, 1
    s_lshl_b32 s18, s58, 8
    s_bitcmp1_b32 s62, 31
    s_cbranch_scc1 L_nok0
    buffer_load_dwordx4 v214, s[16:19], s32 offen offset:0  lds
    buffer_load_dwordx4 v215, s[16:19], s32 offen offset:1024  lds
L_nok0:
    s_bfe_u32 s58, s62, 327698
    s_lshl_b32 s58, s58, 16
    s_sub_u32 s58, s32, s58
    s_bfe_u32 s91, s62, 196633
    s_bfe_u32 s54, s62, 131095
    s_mul_i32 s55, s91, s28
    s_cmp_lt_u32 s28, s54
    s_addc_u32 s91, s91, 0
    s_min_u32 s54, s54, s28
    s_add_u32 s54, s54, s55
    s_lshl_b32 s54, s54, 16
    s_add_u32 s83, s54, s58
    s_lshl_b32 s54, s91, 16
    s_add_u32 s54, s54, s83
    s_sub_u32 s54, s54, 3840
    s_min_u32 s87, s54, s18
    s_mov_b32 s14, s87
    s_mov_b32 s35, s83
    s_bitcmp1_b32 s62, 31
    s_cbranch_scc1 L_mini_end
    s_mov_b32 m0, s30
    s_nop 0
    buffer_load_dwordx4 v216, s[12:15], s35 offen offset:0 nt lds
    s_add_u32 m0, m0, 1056
    s_add_u32 s35, s35, 16384
    buffer_load_dwordx4 v216, s[12:15], s35 offen offset:0 nt lds
    s_add_u32 m0, m0, 1056
    s_add_u32 s35, s35, 16384
    buffer_load_dwordx4 v216, s[12:15], s35 offen offset:0 nt lds
    s_add_u32 m0, m0, 1056
    s_add_u32 s35, s35, 16384
    buffer_load_dwordx4 v216, s[12:15], s35 offen offset:0 nt lds
    s_add_u32 m0, m0, 1056
    s_add_u32 s35, s35, 16384
    s_bitcmp1_b32 s62, 30
    s_cbranch_scc1 L_mini_end
    buffer_load_dwordx4 v216, s[12:15], s35 offen offset:0 nt lds
    s_add_u32 m0, m0, 1056
    s_add_u32 s35, s35, 16384
    buffer_load_dwordx4 v216, s[12:15], s35 offen offset:0 nt lds
    s_add_u32 m0, m0, 1056
    s_add_u32 s35, s35, 16384
    buffer_load_dwordx4 v216, s[12:15], s35 offen offset:0 nt lds
    s_add_u32 m0, m0, 1056
    s_add_u32 s35, s35, 16384
    buffer_load_dwordx4 v216, s[12:15], s35 offen offset:0 nt lds
    s_add_u32 m0, m0, 1056
    s_add_u32 s35, s35, 16384
    s_branch L_mini_end
.type L_mini,@object
L_mini:
.long 0x45f1eb3d
.long 0x4545eb3d
.long 0xd5f1eb3d
.long 0x5545eb3d
.long 0x8545eb3d
.long 0x266b100c
.long 0x5545eb3d
.long 0x366b100c
.long 0x243b100c
.long 0x243b100c
.long 0x443c2388
.long 0x241b100c
.long 0x241b100c
.long 0x043c2388
.long 0x341b100c
.long 0x143c2388
.long 0x666b100c
.long 0x84e02388
.long 0x766b100c
.long 0x54e02388
.long 0x84e02388
.long 0x465a661b
.long 0x94e02388
.long 0x565a661b
.long 0xc41deb3d
.long 0xf41b100c
.long 0xd41deb3d
.long 0x041c2388
.long 0xd43c2388
.long 0x2679adfb
.long 0xd41c2388
.long 0x3679adfb
.long 0xc65a661b
.long 0x462a661b
.long 0x965a661b
.long 0xa525076f
.long 0x062a661b
.long 0x65d1076f
.long 0x962a661b
.long 0xb5d1076f
.long 0x343b100c
.long 0x341b4962
.long 0x441c2388
.long 0x741dadfb
.long 0xa41dadfb
.long 0x641dadfb
.long 0xf41dadfb
.long 0x441deb3d
.long 0xa5d1076f
.long 0x7525076f
.long 0xb5d1076f
.long 0x162a661b
.long 0xe525076f
.long 0x364b41ed
.long 0xf525076f
.long 0x364b4962
.long 0x6679adfb
.long 0x25c9adfb
.long 0x7679adfb
.long 0x35c9adfb
.long 0x65c9adfb
.long 0x45f1eb3d
.long 0xf5c9adfb
.long 0x55f1eb3d
.size L_mini, 256
.type L_mini_end,@function
L_mini_end:
    s_mov_b32 s31, s32
    s_mov_b32 s22, s18
    s_sub_u32 s32, s32, 131072
    v_lshrrev_b32 v244, 2, v241
    v_and_b32 v245, 3, v241
    v_xor_b32 v246, v243, v241
    v_lshlrev_b32 v246, 4, v246
    v_lshl_add_u32 v246, v244, 11, v246
    v_lshl_add_u32 v200, v245, 8, v246
    v_xor_b32 v201, 64, v200
    v_xor_b32 v202, 128, v200
    v_xor_b32 v203, 192, v200
    v_and_b32 v246, 4, v222
    v_add_u32 v246, v246, v244
    v_lshlrev_b32 v246, 5, v246
    v_lshl_add_u32 v246, v245, 3, v246
    v_lshl_add_u32 v246, v244, 8, v246
    v_lshl_add_u32 v246, v243, 11, v246
    v_add_u32 v204, 40960, v246
    v_xor_b32 v205, 32, v204
    v_xor_b32 v206, 64, v204
    v_xor_b32 v207, 96, v204
    v_xor_b32 v208, 128, v204
    v_xor_b32 v209, 160, v204
    v_xor_b32 v210, 192, v204
    v_xor_b32 v211, 224, v204
    v_accvgpr_write_b32 a108, 0
    v_accvgpr_write_b32 a109, 0
    v_accvgpr_write_b32 a110, 0
    v_accvgpr_write_b32 a111, 0
    v_mov_b32 v246, 0x3f803f80
    v_accvgpr_write_b32 a104, v246
    v_accvgpr_write_b32 a105, v246
    v_accvgpr_write_b32 a106, v246
    v_accvgpr_write_b32 a107, v246
    v_mfma_f32_32x32x16_bf16 v[0:15], a[108:111], a[108:111], 0
    v_mul_u32_u24 v246, 1056, v244
    v_lshl_add_u32 v246, v245, 8, v246
    v_lshl_add_u32 v246, v243, 4, v246
    v_add_u32 v246, s30, v246
    v_xor_b32 v247, 0, v245
    v_lshl_add_u32 v217, v247, 6, v246
    v_mfma_f32_32x32x16_bf16 v[16:31], a[108:111], a[108:111], 0
    v_xor_b32 v247, 1, v245
    v_lshl_add_u32 v218, v247, 6, v246
    v_xor_b32 v247, 2, v245
    v_lshl_add_u32 v219, v247, 6, v246
    v_xor_b32 v247, 3, v245
    v_lshl_add_u32 v220, v247, 6, v246
    v_mfma_f32_32x32x16_bf16 v[32:47], a[108:111], a[108:111], 0
    v_lshlrev_b32 v246, 4, v241
    v_lshl_add_u32 v223, v243, 14, v246
    v_mfma_f32_32x32x16_bf16 v[48:63], a[108:111], a[108:111], 0
    v_mfma_f32_32x32x16_bf16 v[64:79], a[108:111], a[108:111], 0
    v_mfma_f32_32x32x16_bf16 v[80:95], a[108:111], a[108:111], 0
    s_cmp_ge_u32 s62, 1073741824
    s_cbranch_scc1 L_thirda
    s_cmp_gt_u32 s91, 2
    s_cbranch_scc1 L_third3a
    s_add_u32 m0, s29, 73728
    s_nop 0
    buffer_load_dwordx4 v212, s[20:23], s31 offen offset:0  lds
    buffer_load_dwordx4 v213, s[20:23], s31 offen offset:1024  lds
    s_add_u32 m0, s29, 32768
    s_nop 0
    buffer_load_dwordx4 v214, s[16:19], s32 offen offset:0  lds
    buffer_load_dwordx4 v215, s[16:19], s32 offen offset:1024  lds
    s_mov_b32 s31, s32
    s_mov_b32 s22, s18
    s_sub_u32 s32, s32, 131072
    s_branch L_thirda
L_third3a:
    buffer_load_dwordx4 v216, s[12:15], s35 offen offset:0 nt lds
    s_add_u32 m0, m0, 1056
    s_add_u32 s35, s35, 16384
    buffer_load_dwordx4 v216, s[12:15], s35 offen offset:0 nt lds
    s_add_u32 m0, m0, 1056
    s_add_u32 s35, s35, 16384
    buffer_load_dwordx4 v216, s[12:15], s35 offen offset:0 nt lds
    s_add_u32 m0, m0, 1056
    s_add_u32 s35, s35, 16384
    buffer_load_dwordx4 v216, s[12:15], s35 offen offset:0 nt lds
    s_add_u32 m0, m0, 1056
    s_add_u32 s35, s35, 16384
L_thirda:
    s_waitcnt lgkmcnt(0)
    s_mov_b32 s33, s65
    s_mov_b32 s82, s67
    s_mov_b32 s50, s83
    s_mov_b32 s53, s87
    s_mov_b32 s84, s91
    s_bfe_u32 s88, s82, 262161
    s_add_u32 s88, s88, 1
    s_bfe_u32 s45, s82, 393237
    s_bfe_u32 s86, s82, 327683
    s_sub_u32 s89, s88, s86
    s_and_b32 s85, s82, 7
    s_cselect_b32 s86, s86, 0
    s_sub_u32 s86, s86, 1
    s_and_b32 s54, s71, 0x1ff00
    s_add_u32 s34, s68, s54
    s_mov_b64 s[80:81], s[68:69]
    s_mov_b32 s46, 0x3e0293ee
    s_mov_b32 s47, 0x3e0293ee
    v_cvt_f32_u32 v244, s45
    v_sub_f32 v244, 0, v244
    v_accvgpr_write_b32 a88, v244
    v_accvgpr_write_b32 a92, v244
    v_accvgpr_write_b32 a96, v244
    v_accvgpr_write_b32 a100, v244
    s_mov_b64 vcc, -1
    s_cmp_le_u32 s77, 0
    s_cbranch_scc1 L_later
    v_and_b32 v241, 15, v221
    v_bfe_u32 v243, v221, 4, 2
    v_lshrrev_b32 v244, 2, v241
    v_lshlrev_b32 v246, 3, v241
    v_and_b32 v246, 16, v246
    v_mov_b32 v247, 0x3f80
    v_lshlrev_b32 v246, v246, v247
    v_and_b32 v247, 1, v241
    v_lshlrev_b32 v247, 1, v247
    v_sub_u32 v247, v243, v247
    v_lshl_add_u32 v247, v247, 2, v244
    s_cmp_le_u32 s77, 1
    s_cbranch_scc1 L_later
    v_cmp_eq_u32 s[54:55], 0, v247
    v_cmp_eq_u32 s[56:57], 1, v247
    v_cmp_eq_u32 s[58:59], 2, v247
    v_cndmask_b32 v240, 0, v246, s[54:55]
    v_cndmask_b32 v241, 0, v246, s[56:57]
    v_cndmask_b32 v242, 0, v246, s[58:59]
    v_accvgpr_write_b32 a64, v240
    v_accvgpr_write_b32 a65, v241
    v_accvgpr_write_b32 a66, v242
    s_cmp_le_u32 s77, 2
    s_cbranch_scc1 L_later
    v_cmp_eq_u32 s[54:55], 3, v247
    v_cmp_eq_u32 s[56:57], 4, v247
    v_cmp_eq_u32 s[58:59], 5, v247
    v_cndmask_b32 v240, 0, v246, s[54:55]
    v_cndmask_b32 v241, 0, v246, s[56:57]
    v_cndmask_b32 v242, 0, v246, s[58:59]
    v_accvgpr_write_b32 a67, v240
    v_accvgpr_write_b32 a68, v241
    v_accvgpr_write_b32 a69, v242
    s_cmp_le_u32 s77, 3
    s_cbranch_scc1 L_later
    v_cmp_eq_u32 s[54:55], 6, v247
    v_cmp_eq_u32 s[56:57], 7, v247
    s_nop 0
    v_cndmask_b32 v240, 0, v246, s[54:55]
    v_cndmask_b32 v241, 0, v246, s[56:57]
    v_accvgpr_write_b32 a70, v240
    v_accvgpr_write_b32 a71, v241
    s_mov_b32 s51, 1023410176
    s_mov_b32 s52, 578813952
    s_mov_b32 s40, 0
    s_mov_b32 s41, 1
    s_mov_b64 vcc, 0
L_later:
    s_cmp_lt_u32 s62, 1073741824
    s_cbranch_scc1 L_nw0
    s_bitcmp1_b32 s62, 31
    s_cbranch_scc0 L_nw1
    buffer_load_dwordx4 v214, s[16:19], s31 offen offset:0  lds
    buffer_load_dwordx4 v215, s[16:19], s31 offen offset:1024  lds
    s_mov_b32 m0, s30
    s_nop 0
    buffer_load_dwordx4 v216, s[12:15], s35 offen offset:0 nt lds
    s_add_u32 m0, m0, 1056
    s_add_u32 s35, s35, 16384
    buffer_load_dwordx4 v216, s[12:15], s35 offen offset:0 nt lds
    s_add_u32 m0, m0, 1056
    s_add_u32 s35, s35, 16384
    buffer_load_dwordx4 v216, s[12:15], s35 offen offset:0 nt lds
    s_add_u32 m0, m0, 1056
    s_add_u32 s35, s35, 16384
    buffer_load_dwordx4 v216, s[12:15], s35 offen offset:0 nt lds
    s_add_u32 m0, m0, 1056
    s_add_u32 s35, s35, 16384
    s_bitcmp1_b32 s62, 30
    s_cbranch_scc0 L_nw2
L_nw1:
    s_waitcnt vmcnt(0)
L_nw2:
    buffer_load_dwordx4 v216, s[12:15], s35 offen offset:0 nt lds
    s_add_u32 m0, m0, 1056
    s_add_u32 s35, s35, 16384
    buffer_load_dwordx4 v216, s[12:15], s35 offen offset:0 nt lds
    s_add_u32 m0, m0, 1056
    s_add_u32 s35, s35, 16384
    buffer_load_dwordx4 v216, s[12:15], s35 offen offset:0 nt lds
    s_add_u32 m0, m0, 1056
    s_add_u32 s35, s35, 16384
    buffer_load_dwordx4 v216, s[12:15], s35 offen offset:0 nt lds
    s_add_u32 m0, m0, 1056
    s_add_u32 s35, s35, 16384
    s_cmp_gt_u32 s91, 2
    s_cbranch_scc1 L_third3b
    s_add_u32 m0, s29, 73728
    s_nop 0
    buffer_load_dwordx4 v212, s[20:23], s31 offen offset:0  lds
    buffer_load_dwordx4 v213, s[20:23], s31 offen offset:1024  lds
    s_add_u32 m0, s29, 32768
    s_nop 0
    buffer_load_dwordx4 v214, s[16:19], s32 offen offset:0  lds
    buffer_load_dwordx4 v215, s[16:19], s32 offen offset:1024  lds
    s_mov_b32 s31, s32
    s_mov_b32 s22, s18
    s_sub_u32 s32, s32, 131072
    s_branch L_thirdb
L_third3b:
    buffer_load_dwordx4 v216, s[12:15], s35 offen offset:0 nt lds
    s_add_u32 m0, m0, 1056
    s_add_u32 s35, s35, 16384
    buffer_load_dwordx4 v216, s[12:15], s35 offen offset:0 nt lds
    s_add_u32 m0, m0, 1056
    s_add_u32 s35, s35, 16384
    buffer_load_dwordx4 v216, s[12:15], s35 offen offset:0 nt lds
    s_add_u32 m0, m0, 1056
    s_add_u32 s35, s35, 16384
    buffer_load_dwordx4 v216, s[12:15], s35 offen offset:0 nt lds
    s_add_u32 m0, m0, 1056
    s_add_u32 s35, s35, 16384
L_thirdb:
L_nw0:
    s_cmp_eq_u32 s84, 2
    s_cbranch_scc1 L_first2
    s_branch L_first3
L_ev:
    s_lshr_b32 s63, s39, 13
    s_cbranch_vccz L_dfr
    s_add_u32 s77, s77, 1
    s_cmp_eq_u32 s77, 1
    s_cbranch_scc1 L_ch0
    s_cmp_eq_u32 s77, 2
    s_cbranch_scc1 L_ch1
    s_cmp_eq_u32 s77, 3
    s_cbranch_scc1 L_ch2
    s_branch L_ch3
L_dfr:
    s_cmp_ge_i32 s86, s88
    s_cbranch_scc0 L_xare
    s_mov_b32 s56, s85
L_xale:
    s_mov_b32 m0, s36
    s_sub_u32 s56, s56, 1
    buffer_load_dwordx4 v216, s[12:15], s35 offen offset:0 nt lds
    s_add_u32 s35, s35, 16384
    s_add_u32 s36, s36, 1056
    s_min_u32 s36, s36, s37
    s_cmp_lg_u32 s56, 0
    s_cbranch_scc1 L_xale
L_xare:
    s_sub_u32 s38, s88, 1
    s_min_i32 s88, s38, s86
    s_max_i32 s88, s88, 0
    s_cmp_lg_u64 vcc, 0
    s_cselect_b32 s88, s38, s88
    s_sub_u32 s38, s38, s88
    s_cmp_eq_u32 s84, 2
    s_cbranch_scc0 L_evn2
    s_cmp_eq_u32 s63, 1
    s_cbranch_scc1 L_body2_1
    s_cmp_eq_u32 s63, 2
    s_cbranch_scc1 L_body2_2
    s_cmp_eq_u32 s63, 3
    s_cbranch_scc1 L_body2_3
    s_cmp_eq_u32 s63, 4
    s_cbranch_scc1 L_body2_4
    s_branch L_body2_0
L_evn2:
    s_cmp_eq_u32 s63, 1
    s_cbranch_scc1 L_body3_1
    s_cmp_eq_u32 s63, 2
    s_cbranch_scc1 L_body3_2
    s_cmp_eq_u32 s63, 3
    s_cbranch_scc1 L_body3_3
    s_cmp_eq_u32 s63, 4
    s_cbranch_scc1 L_body3_4
    s_branch L_body3_0
L_zero2:
    v_mfma_f32_32x32x16_bf16 v[64:79], a[108:111], a[108:111], 0
    v_mfma_f32_32x32x16_bf16 v[80:95], a[108:111], a[108:111], 0
    s_branch L_pro3
L_ch0:
    v_and_b32 v241, 15, v221
    v_bfe_u32 v243, v221, 4, 2
    v_lshrrev_b32 v244, 2, v241
    v_lshlrev_b32 v246, 3, v241
    v_and_b32 v246, 16, v246
    v_mov_b32 v247, 0x3f80
    v_lshlrev_b32 v246, v246, v247
    v_and_b32 v247, 1, v241
    v_lshlrev_b32 v247, 1, v247
    v_sub_u32 v247, v243, v247
    v_lshl_add_u32 v247, v247, 2, v244
    s_branch L_dfr
L_ch1:
    v_cmp_eq_u32 s[54:55], 0, v247
    v_cmp_eq_u32 s[56:57], 1, v247
    v_cmp_eq_u32 s[58:59], 2, v247
    v_cndmask_b32 v240, 0, v246, s[54:55]
    v_cndmask_b32 v241, 0, v246, s[56:57]
    v_cndmask_b32 v242, 0, v246, s[58:59]
    v_accvgpr_write_b32 a64, v240
    v_accvgpr_write_b32 a65, v241
    v_accvgpr_write_b32 a66, v242
    s_branch L_dfr
.p2align 12
L_slow:
    s_getpc_b64 s[54:55]
L_pc2:
    s_add_u32 s56, s90, L_table-L_pc2
    s_load_dwordx16 s[64:79], s[54:55], s56
    s_waitcnt vmcnt(0) lgkmcnt(0)
    s_sub_u32 s54, s30, 32768
    v_add_u32 v228, s30, v200
    v_add_u32 v229, s30, v201
    v_add_u32 v230, s30, v202
    v_add_u32 v231, s30, v203
    v_add_u32 v232, s54, v204
    v_add_u32 v233, s54, v205
    v_add_u32 v234, s54, v206
    v_add_u32 v235, s54, v207
    v_add_u32 v236, s54, v208
    v_add_u32 v237, s54, v209
    v_add_u32 v238, s54, v210
    v_add_u32 v239, s54, v211
    v_and_b32 v241, 15, v221
    v_bfe_u32 v243, v221, 4, 2
    v_add_u32 v242, 0, v243
    v_xor_b32 v244, v242, v241
    v_lshlrev_b32 v244, 4, v244
    v_lshl_add_u32 v32, v242, 12, v244
    v_add_u32 v33, 65536, v32
    v_and_b32 v244, 7, v242
    v_lshlrev_b32 v244, 1, v244
    v_xor_b32 v244, v244, v241
    v_lshlrev_b32 v244, 4, v244
    v_lshl_add_u32 v40, v242, 12, v244
    v_add_u32 v41, 65536, v40
    v_add_u32 v242, 4, v243
    v_xor_b32 v244, v242, v241
    v_lshlrev_b32 v244, 4, v244
    v_lshl_add_u32 v34, v242, 12, v244
    v_add_u32 v35, 65536, v34
    v_and_b32 v244, 7, v242
    v_lshlrev_b32 v244, 1, v244
    v_xor_b32 v244, v244, v241
    v_lshlrev_b32 v244, 4, v244
    v_lshl_add_u32 v42, v242, 12, v244
    v_add_u32 v43, 65536, v42
    v_add_u32 v242, 8, v243
    v_xor_b32 v244, v242, v241
    v_lshlrev_b32 v244, 4, v244
    v_lshl_add_u32 v36, v242, 12, v244
    v_add_u32 v37, 65536, v36
    v_and_b32 v244, 7, v242
    v_lshlrev_b32 v244, 1, v244
    v_xor_b32 v244, v244, v241
    v_lshlrev_b32 v244, 4, v244
    v_lshl_add_u32 v44, v242, 12, v244
    v_add_u32 v45, 65536, v44
    v_add_u32 v242, 12, v243
    v_xor_b32 v244, v242, v241
    v_lshlrev_b32 v244, 4, v244
    v_lshl_add_u32 v38, v242, 12, v244
    v_add_u32 v39, 65536, v38
    v_and_b32 v244, 7, v242
    v_lshlrev_b32 v244, 1, v244
    v_xor_b32 v244, v244, v241
    v_lshlrev_b32 v244, 4, v244
    v_lshl_add_u32 v46, v242, 12, v244
    v_add_u32 v47, 65536, v46
    v_lshlrev_b32 v48, 4, v243
    v_lshl_add_u32 v48, v241, 12, v48
    v_mov_b32 v65, 0xff800000
L_slow_job:
    s_bitcmp1_b32 s40, 0
    s_cbranch_scc0 L_slow_next
    s_and_b32 s54, s67, 0x1ff00
    s_add_u32 s14, s64, s54
    s_add_u32 s18, s64, s54
    s_add_u32 s22, s64, s54
    s_add_u32 s26, s64, s54
    s_add_u32 s64, s65, 131072
    s_sub_u32 s86, s18, s64
    s_add_u32 s86, s86, 3840
    s_lshr_b32 s86, s86, 12
    s_bfe_u32 s91, s67, 196637
    s_bfe_u32 s54, s67, 131099
    s_mul_i32 s55, s91, s28
    s_cmp_lt_u32 s28, s54
    s_addc_u32 s91, s91, 0
    s_min_u32 s54, s54, s28
    s_add_u32 s54, s54, s55
    s_lshl_b32 s54, s54, 16
    s_add_u32 s83, s54, s66
    s_lshl_b32 s54, s91, 16
    s_add_u32 s54, s54, s83
    s_sub_u32 s54, s54, 3840
    s_min_u32 s87, s54, s18
    s_mov_b32 s44, s83
L_slow_sub:
    buffer_load_dwordx4 v[152:155], v48, s[12:15], s44 offen offset:0
    buffer_load_dwordx4 v[156:159], v48, s[12:15], s44 offen offset:64
    buffer_load_dwordx4 v[160:163], v48, s[12:15], s44 offen offset:128
    buffer_load_dwordx4 v[164:167], v48, s[12:15], s44 offen offset:192
    v_mov_b32 v0, 0
    v_mov_b32 v1, 0
    v_mov_b32 v2, 0
    v_mov_b32 v3, 0
    v_mov_b32 v4, 0
    v_mov_b32 v5, 0
    v_mov_b32 v6, 0
    v_mov_b32 v7, 0
    v_mov_b32 v8, 0
    v_mov_b32 v9, 0
    v_mov_b32 v10, 0
    v_mov_b32 v11, 0
    v_mov_b32 v12, 0
    v_mov_b32 v13, 0
    v_mov_b32 v14, 0
    v_mov_b32 v15, 0
    v_mov_b32 v16, 0
    v_mov_b32 v17, 0
    v_mov_b32 v18, 0
    v_mov_b32 v19, 0
    v_mov_b32 v20, 0
    v_mov_b32 v21, 0
    v_mov_b32 v22, 0
    v_mov_b32 v23, 0
    v_mov_b32 v24, 0
    v_mov_b32 v25, 0
    v_mov_b32 v26, 0
    v_mov_b32 v27, 0
    v_mov_b32 v28, 0
    v_mov_b32 v29, 0
    v_mov_b32 v30, 0
    v_mov_b32 v31, 0
    v_accvgpr_write_b32 a88, 0
    v_mov_b32 v64, v65
    s_waitcnt vmcnt(0)
    v_lshlrev_b32 v240, 16, v152
    v_and_b32 v241, 0xffff0000, v152
    v_pk_mul_f32 v[240:241], v[240:241], s[46:47]
    v_cvt_pk_bf16_f32 v152, v240, v241
    v_lshlrev_b32 v242, 16, v153
    v_and_b32 v243, 0xffff0000, v153
    v_pk_mul_f32 v[242:243], v[242:243], s[46:47]
    v_cvt_pk_bf16_f32 v153, v242, v243
    v_lshlrev_b32 v240, 16, v154
    v_and_b32 v241, 0xffff0000, v154
    v_pk_mul_f32 v[240:241], v[240:241], s[46:47]
    v_cvt_pk_bf16_f32 v154, v240, v241
    v_lshlrev_b32 v242, 16, v155
    v_and_b32 v243, 0xffff0000, v155
    v_pk_mul_f32 v[242:243], v[242:243], s[46:47]
    v_cvt_pk_bf16_f32 v155, v242, v243
    v_lshlrev_b32 v240, 16, v156
    v_and_b32 v241, 0xffff0000, v156
    v_pk_mul_f32 v[240:241], v[240:241], s[46:47]
    v_cvt_pk_bf16_f32 v156, v240, v241
    v_lshlrev_b32 v242, 16, v157
    v_and_b32 v243, 0xffff0000, v157
    v_pk_mul_f32 v[242:243], v[242:243], s[46:47]
    v_cvt_pk_bf16_f32 v157, v242, v243
    v_lshlrev_b32 v240, 16, v158
    v_and_b32 v241, 0xffff0000, v158
    v_pk_mul_f32 v[240:241], v[240:241], s[46:47]
    v_cvt_pk_bf16_f32 v158, v240, v241
    v_lshlrev_b32 v242, 16, v159
    v_and_b32 v243, 0xffff0000, v159
    v_pk_mul_f32 v[242:243], v[242:243], s[46:47]
    v_cvt_pk_bf16_f32 v159, v242, v243
    v_lshlrev_b32 v240, 16, v160
    v_and_b32 v241, 0xffff0000, v160
    v_pk_mul_f32 v[240:241], v[240:241], s[46:47]
    v_cvt_pk_bf16_f32 v160, v240, v241
    v_lshlrev_b32 v242, 16, v161
    v_and_b32 v243, 0xffff0000, v161
    v_pk_mul_f32 v[242:243], v[242:243], s[46:47]
    v_cvt_pk_bf16_f32 v161, v242, v243
    v_lshlrev_b32 v240, 16, v162
    v_and_b32 v241, 0xffff0000, v162
    v_pk_mul_f32 v[240:241], v[240:241], s[46:47]
    v_cvt_pk_bf16_f32 v162, v240, v241
    v_lshlrev_b32 v242, 16, v163
    v_and_b32 v243, 0xffff0000, v163
    v_pk_mul_f32 v[242:243], v[242:243], s[46:47]
    v_cvt_pk_bf16_f32 v163, v242, v243
    v_lshlrev_b32 v240, 16, v164
    v_and_b32 v241, 0xffff0000, v164
    v_pk_mul_f32 v[240:241], v[240:241], s[46:47]
    v_cvt_pk_bf16_f32 v164, v240, v241
    v_lshlrev_b32 v242, 16, v165
    v_and_b32 v243, 0xffff0000, v165
    v_pk_mul_f32 v[242:243], v[242:243], s[46:47]
    v_cvt_pk_bf16_f32 v165, v242, v243
    v_lshlrev_b32 v240, 16, v166
    v_and_b32 v241, 0xffff0000, v166
    v_pk_mul_f32 v[240:241], v[240:241], s[46:47]
    v_cvt_pk_bf16_f32 v166, v240, v241
    v_lshlrev_b32 v242, 16, v167
    v_and_b32 v243, 0xffff0000, v167
    v_pk_mul_f32 v[242:243], v[242:243], s[46:47]
    v_cvt_pk_bf16_f32 v167, v242, v243
    s_mov_b32 s89, 0
L_slow_pass:
    s_mov_b32 s88, s64
    s_mov_b32 s45, s86
L_slow_tile:
    s_mov_b32 m0, s30
    s_nop 0
    buffer_load_dwordx4 v32, s[16:19], s88 offen offset:0  lds
    s_add_u32 m0, m0, 1024
    s_nop 0
    buffer_load_dwordx4 v33, s[16:19], s88 offen offset:0  lds
    s_add_u32 m0, m0, 1024
    s_nop 0
    buffer_load_dwordx4 v34, s[16:19], s88 offen offset:0  lds
    s_add_u32 m0, m0, 1024
    s_nop 0
    buffer_load_dwordx4 v35, s[16:19], s88 offen offset:0  lds
    s_add_u32 m0, m0, 1024
    s_nop 0
    buffer_load_dwordx4 v36, s[16:19], s88 offen offset:0  lds
    s_add_u32 m0, m0, 1024
    s_nop 0
    buffer_load_dwordx4 v37, s[16:19], s88 offen offset:0  lds
    s_add_u32 m0, m0, 1024
    s_nop 0
    buffer_load_dwordx4 v38, s[16:19], s88 offen offset:0  lds
    s_add_u32 m0, m0, 1024
    s_nop 0
    buffer_load_dwordx4 v39, s[16:19], s88 offen offset:0  lds
    s_add_u32 m0, m0, 1024
    s_nop 0
    buffer_load_dwordx4 v40, s[20:23], s88 offen offset:0  lds
    s_add_u32 m0, m0, 1024
    s_nop 0
    buffer_load_dwordx4 v41, s[20:23], s88 offen offset:0  lds
    s_add_u32 m0, m0, 1024
    s_nop 0
    buffer_load_dwordx4 v42, s[20:23], s88 offen offset:0  lds
    s_add_u32 m0, m0, 1024
    s_nop 0
    buffer_load_dwordx4 v43, s[20:23], s88 offen offset:0  lds
    s_add_u32 m0, m0, 1024
    s_nop 0
    buffer_load_dwordx4 v44, s[20:23], s88 offen offset:0  lds
    s_add_u32 m0, m0, 1024
    s_nop 0
    buffer_load_dwordx4 v45, s[20:23], s88 offen offset:0  lds
    s_add_u32 m0, m0, 1024
    s_nop 0
    buffer_load_dwordx4 v46, s[20:23], s88 offen offset:0  lds
    s_add_u32 m0, m0, 1024
    s_nop 0
    buffer_load_dwordx4 v47, s[20:23], s88 offen offset:0  lds
    s_add_u32 m0, m0, 1024
    s_nop 0
    s_waitcnt vmcnt(0)
    ds_read_b128 a[0:3], v228 offset:0
    ds_read_b128 a[4:7], v229 offset:0
    ds_read_b128 a[8:11], v230 offset:0
    ds_read_b128 a[12:15], v231 offset:0
    ds_read_b128 a[16:19], v228 offset:1024
    ds_read_b128 a[20:23], v229 offset:1024
    ds_read_b128 a[24:27], v230 offset:1024
    ds_read_b128 a[28:31], v231 offset:1024
    s_waitcnt lgkmcnt(0)
    ds_read_b64_tr_b16 a[32:33], v232 offset:0
    ds_read_b64_tr_b16 a[34:35], v232 offset:1024
    ds_read_b64_tr_b16 a[36:37], v233 offset:0
    ds_read_b64_tr_b16 a[38:39], v233 offset:1024
    ds_read_b64_tr_b16 a[40:41], v234 offset:0
    ds_read_b64_tr_b16 a[42:43], v234 offset:1024
    ds_read_b64_tr_b16 a[44:45], v235 offset:0
    ds_read_b64_tr_b16 a[46:47], v235 offset:1024
    s_waitcnt lgkmcnt(0)
    ds_read_b64_tr_b16 a[48:49], v236 offset:0
    ds_read_b64_tr_b16 a[50:51], v236 offset:1024
    ds_read_b64_tr_b16 a[52:53], v237 offset:0
    ds_read_b64_tr_b16 a[54:55], v237 offset:1024
    ds_read_b64_tr_b16 a[56:57], v238 offset:0
    ds_read_b64_tr_b16 a[58:59], v238 offset:1024
    ds_read_b64_tr_b16 a[60:61], v239 offset:0
    ds_read_b64_tr_b16 a[62:63], v239 offset:1024
    v_mfma_f32_16x16x32_bf16 v[128:131], a[0:3], v[152:155], 0
    v_mfma_f32_16x16x32_bf16 v[128:131], a[4:7], v[156:159], v[128:131]
    v_mfma_f32_16x16x32_bf16 v[128:131], a[8:11], v[160:163], v[128:131]
    v_mfma_f32_16x16x32_bf16 v[128:131], a[12:15], v[164:167], v[128:131]
    v_mfma_f32_16x16x32_bf16 v[132:135], a[16:19], v[152:155], 0
    v_mfma_f32_16x16x32_bf16 v[132:135], a[20:23], v[156:159], v[132:135]
    v_mfma_f32_16x16x32_bf16 v[132:135], a[24:27], v[160:163], v[132:135]
    v_mfma_f32_16x16x32_bf16 v[132:135], a[28:31], v[164:167], v[132:135]
    v_sub_u32 v240, s45, v222
    s_nop 7
    v_cmp_lt_i32 vcc, 0, v240
    s_nop 1
    v_cndmask_b32 v128, v65, v128, vcc
    v_cmp_lt_i32 vcc, 1, v240
    s_nop 1
    v_cndmask_b32 v129, v65, v129, vcc
    v_cmp_lt_i32 vcc, 2, v240
    s_nop 1
    v_cndmask_b32 v130, v65, v130, vcc
    v_cmp_lt_i32 vcc, 3, v240
    s_nop 1
    v_cndmask_b32 v131, v65, v131, vcc
    v_cmp_lt_i32 vcc, 16, v240
    s_nop 1
    v_cndmask_b32 v132, v65, v132, vcc
    v_cmp_lt_i32 vcc, 17, v240
    s_nop 1
    v_cndmask_b32 v133, v65, v133, vcc
    v_cmp_lt_i32 vcc, 18, v240
    s_nop 1
    v_cndmask_b32 v134, v65, v134, vcc
    v_cmp_lt_i32 vcc, 19, v240
    s_nop 1
    v_cndmask_b32 v135, v65, v135, vcc
    s_waitcnt lgkmcnt(0)
    s_cmp_eq_u32 s89, 1
    s_cbranch_scc1 L_slow_p2
    v_max3_f32 v64, v64, v128, v129
    v_max3_f32 v64, v64, v130, v131
    v_max3_f32 v64, v64, v132, v133
    v_max3_f32 v64, v64, v134, v135
    s_branch L_slow_adv
L_slow_p2:
    v_sub_f32 v128, v128, v64
    v_sub_f32 v129, v129, v64
    v_sub_f32 v130, v130, v64
    v_sub_f32 v131, v131, v64
    v_sub_f32 v132, v132, v64
    v_sub_f32 v133, v133, v64
    v_sub_f32 v134, v134, v64
    v_sub_f32 v135, v135, v64
    v_exp_f32 v128, v128
    v_exp_f32 v129, v129
    v_exp_f32 v130, v130
    v_exp_f32 v131, v131
    v_exp_f32 v132, v132
    v_exp_f32 v133, v133
    v_exp_f32 v134, v134
    v_exp_f32 v135, v135
    s_nop 0
    v_cvt_pk_bf16_f32 v144, v128, v129
    v_cvt_pk_bf16_f32 v145, v130, v131
    v_cvt_pk_bf16_f32 v146, v132, v133
    v_cvt_pk_bf16_f32 v147, v134, v135
    s_nop 1
    v_mfma_f32_16x16x32_bf16 v[0:3], a[32:35], v[144:147], v[0:3]
    v_mfma_f32_16x16x32_bf16 v[4:7], a[36:39], v[144:147], v[4:7]
    v_mfma_f32_16x16x32_bf16 v[8:11], a[40:43], v[144:147], v[8:11]
    v_mfma_f32_16x16x32_bf16 v[12:15], a[44:47], v[144:147], v[12:15]
    v_mfma_f32_16x16x32_bf16 v[16:19], a[48:51], v[144:147], v[16:19]
    v_mfma_f32_16x16x32_bf16 v[20:23], a[52:55], v[144:147], v[20:23]
    v_mfma_f32_16x16x32_bf16 v[24:27], a[56:59], v[144:147], v[24:27]
    v_mfma_f32_16x16x32_bf16 v[28:31], a[60:63], v[144:147], v[28:31]
    v_mfma_f32_16x16x32_bf16 a[88:91], a[104:107], v[144:147], a[88:91]
L_slow_adv:
    s_add_u32 s88, s88, 131072
    s_sub_u32 s45, s45, 32
    s_cmp_gt_i32 s45, 0
    s_cbranch_scc1 L_slow_tile
    s_cmp_eq_u32 s89, 1
    s_cbranch_scc1 L_slow_out
    v_mov_b32 v240, v64
    s_nop 1
    v_permlane32_swap_b32 v64, v240
    s_nop 1
    v_max_f32 v64, v64, v240
    v_mov_b32 v240, v64
    s_nop 1
    v_permlane16_swap_b32 v64, v240
    s_nop 1
    v_max_f32 v64, v64, v240
    s_mov_b32 s89, 1
    s_branch L_slow_pass
L_slow_out:
    s_nop 7
    v_accvgpr_read_b32 v250, a88
    v_rcp_f32 v248, v250
    s_nop 0
    v_pk_mul_f32 v[0:1], v[0:1], v[248:249] op_sel_hi:[1,0]
    v_pk_mul_f32 v[2:3], v[2:3], v[248:249] op_sel_hi:[1,0]
    v_pk_mul_f32 v[4:5], v[4:5], v[248:249] op_sel_hi:[1,0]
    v_pk_mul_f32 v[6:7], v[6:7], v[248:249] op_sel_hi:[1,0]
    v_pk_mul_f32 v[8:9], v[8:9], v[248:249] op_sel_hi:[1,0]
    v_pk_mul_f32 v[10:11], v[10:11], v[248:249] op_sel_hi:[1,0]
    v_pk_mul_f32 v[12:13], v[12:13], v[248:249] op_sel_hi:[1,0]
    v_pk_mul_f32 v[14:15], v[14:15], v[248:249] op_sel_hi:[1,0]
    v_pk_mul_f32 v[16:17], v[16:17], v[248:249] op_sel_hi:[1,0]
    v_pk_mul_f32 v[18:19], v[18:19], v[248:249] op_sel_hi:[1,0]
    v_pk_mul_f32 v[20:21], v[20:21], v[248:249] op_sel_hi:[1,0]
    v_pk_mul_f32 v[22:23], v[22:23], v[248:249] op_sel_hi:[1,0]
    v_pk_mul_f32 v[24:25], v[24:25], v[248:249] op_sel_hi:[1,0]
    v_pk_mul_f32 v[26:27], v[26:27], v[248:249] op_sel_hi:[1,0]
    v_pk_mul_f32 v[28:29], v[28:29], v[248:249] op_sel_hi:[1,0]
    v_pk_mul_f32 v[30:31], v[30:31], v[248:249] op_sel_hi:[1,0]
    v_cvt_pk_bf16_f32 v184, v0, v4
    v_cvt_pk_bf16_f32 v185, v8, v12
    v_cvt_pk_bf16_f32 v186, v16, v20
    v_cvt_pk_bf16_f32 v187, v24, v28
    v_cvt_pk_bf16_f32 v188, v1, v5
    v_cvt_pk_bf16_f32 v189, v9, v13
    v_cvt_pk_bf16_f32 v190, v17, v21
    v_cvt_pk_bf16_f32 v191, v25, v29
    v_mfma_f32_16x16x32_bf16 v[128:131], v[184:187], a[64:67], 0
    v_cvt_pk_bf16_f32 v192, v2, v6
    v_cvt_pk_bf16_f32 v193, v10, v14
    v_mfma_f32_16x16x32_bf16 v[144:147], v[184:187], a[68:71], 0
    v_cvt_pk_bf16_f32 v194, v18, v22
    v_cvt_pk_bf16_f32 v195, v26, v30
    v_mfma_f32_16x16x32_bf16 v[132:135], v[188:191], a[64:67], 0
    v_cvt_pk_bf16_f32 v196, v3, v7
    v_cvt_pk_bf16_f32 v197, v11, v15
    v_mfma_f32_16x16x32_bf16 v[148:151], v[188:191], a[68:71], 0
    v_cvt_pk_bf16_f32 v198, v19, v23
    v_cvt_pk_bf16_f32 v199, v27, v31
    v_mfma_f32_16x16x32_bf16 v[136:139], v[192:195], a[64:67], 0
    s_nop 0
    v_mfma_f32_16x16x32_bf16 v[224:227], v[192:195], a[68:71], 0
    s_nop 0
    v_mfma_f32_16x16x32_bf16 v[140:143], v[196:199], a[64:67], 0
    v_cvt_pk_bf16_f32 v0, v128, v132
    v_cvt_pk_bf16_f32 v4, v129, v133
    v_mfma_f32_16x16x32_bf16 v[244:247], v[196:199], a[68:71], 0
    v_cvt_pk_bf16_f32 v8, v130, v134
    v_cvt_pk_bf16_f32 v12, v131, v135
    v_cvt_pk_bf16_f32 v2, v144, v148
    v_cvt_pk_bf16_f32 v6, v145, v149
    v_cvt_pk_bf16_f32 v10, v146, v150
    v_cvt_pk_bf16_f32 v14, v147, v151
    v_cvt_pk_bf16_f32 v1, v136, v140
    v_cvt_pk_bf16_f32 v5, v137, v141
    v_cvt_pk_bf16_f32 v9, v138, v142
    v_cvt_pk_bf16_f32 v13, v139, v143
    v_cvt_pk_bf16_f32 v3, v224, v244
    v_cvt_pk_bf16_f32 v7, v225, v245
    v_cvt_pk_bf16_f32 v11, v226, v246
    v_cvt_pk_bf16_f32 v15, v227, v247
    buffer_store_dwordx4 v[0:3], v223, s[24:27], s44 offen sc1
    s_add_u32 s44, s44, 4096
    buffer_store_dwordx4 v[4:7], v223, s[24:27], s44 offen sc1
    s_add_u32 s44, s44, 4096
    buffer_store_dwordx4 v[8:11], v223, s[24:27], s44 offen sc1
    s_add_u32 s44, s44, 4096
    buffer_store_dwordx4 v[12:15], v223, s[24:27], s44 offen sc1
    s_add_u32 s44, s44, 53248
    s_waitcnt vmcnt(0)
    s_sub_u32 s91, s91, 1
    s_cmp_lg_u32 s91, 0
    s_cbranch_scc1 L_slow_sub
L_slow_next:
    s_mov_b64 s[64:65], s[68:69]
    s_mov_b64 s[66:67], s[70:71]
    s_mov_b64 s[68:69], s[72:73]
    s_mov_b64 s[70:71], s[74:75]
    s_lshr_b32 s40, s40, 1
    s_cmp_lg_u32 s40, 0
    s_cbranch_scc1 L_slow_job
    s_endpgm
.fill 10, 4, 0xbf810000
L_first2:
    s_waitcnt vmcnt(8)
    ds_read_b128 v[152:155], v217 offset:0
    ds_read_b128 v[156:159], v218 offset:0
    ds_read_b128 v[160:163], v219 offset:0
    ds_read_b128 v[164:167], v220 offset:0
    s_bfe_u32 s91, s71, 196637
    s_bfe_u32 s54, s71, 131099
    s_mul_i32 s55, s91, s28
    s_cmp_lt_u32 s28, s54
    s_addc_u32 s91, s91, 0
    s_waitcnt lgkmcnt(3)
    v_lshlrev_b32 v240, 16, v152
    s_min_u32 s54, s54, s28
    v_and_b32 v241, 0xffff0000, v152
    s_add_u32 s54, s54, s55
    v_pk_mul_f32 v[240:241], v[240:241], s[46:47]
    s_lshl_b32 s54, s54, 16
    v_cvt_pk_bf16_f32 v152, v240, v241
    s_add_u32 s83, s54, s70
    v_lshlrev_b32 v242, 16, v153
    s_lshl_b32 s54, s91, 16
    v_and_b32 v243, 0xffff0000, v153
    s_add_u32 s54, s54, s83
    v_pk_mul_f32 v[242:243], v[242:243], s[46:47]
    s_sub_u32 s54, s54, 3840
    v_cvt_pk_bf16_f32 v153, v242, v243
    s_min_u32 s87, s54, s34
    v_lshlrev_b32 v240, 16, v154
    v_and_b32 v241, 0xffff0000, v154
    v_pk_mul_f32 v[240:241], v[240:241], s[46:47]
    v_cvt_pk_bf16_f32 v154, v240, v241
    v_lshlrev_b32 v242, 16, v155
    v_and_b32 v243, 0xffff0000, v155
    v_pk_mul_f32 v[242:243], v[242:243], s[46:47]
    v_cvt_pk_bf16_f32 v155, v242, v243
    s_waitcnt lgkmcnt(2)
    v_lshlrev_b32 v240, 16, v156
    v_and_b32 v241, 0xffff0000, v156
    v_pk_mul_f32 v[240:241], v[240:241], s[46:47]
    v_cvt_pk_bf16_f32 v156, v240, v241
    v_lshlrev_b32 v242, 16, v157
    v_and_b32 v243, 0xffff0000, v157
    v_pk_mul_f32 v[242:243], v[242:243], s[46:47]
    v_cvt_pk_bf16_f32 v157, v242, v243
    v_lshlrev_b32 v240, 16, v158
    v_and_b32 v241, 0xffff0000, v158
    v_pk_mul_f32 v[240:241], v[240:241], s[46:47]
    v_cvt_pk_bf16_f32 v158, v240, v241
    s_barrier
    ds_read_b128 a[0:3], v200 offset:24576
    ds_read_b128 a[4:7], v201 offset:24576
    v_lshlrev_b32 v242, 16, v159
    v_and_b32 v243, 0xffff0000, v159
    v_pk_mul_f32 v[242:243], v[242:243], s[46:47]
    v_cvt_pk_bf16_f32 v159, v242, v243
    s_waitcnt lgkmcnt(3)
    v_lshlrev_b32 v240, 16, v160
    v_and_b32 v241, 0xffff0000, v160
    v_pk_mul_f32 v[240:241], v[240:241], s[46:47]
    v_cvt_pk_bf16_f32 v160, v240, v241
    ds_read_b128 a[8:11], v202 offset:24576
    ds_read_b128 a[12:15], v203 offset:24576
    v_lshlrev_b32 v242, 16, v161
    v_and_b32 v243, 0xffff0000, v161
    v_pk_mul_f32 v[242:243], v[242:243], s[46:47]
    v_cvt_pk_bf16_f32 v161, v242, v243
    v_lshlrev_b32 v240, 16, v162
    v_and_b32 v241, 0xffff0000, v162
    v_pk_mul_f32 v[240:241], v[240:241], s[46:47]
    v_cvt_pk_bf16_f32 v162, v240, v241
    ds_read_b128 a[16:19], v200 offset:25600
    ds_read_b128 a[20:23], v201 offset:25600
    v_lshlrev_b32 v242, 16, v163
    v_and_b32 v243, 0xffff0000, v163
    v_pk_mul_f32 v[242:243], v[242:243], s[46:47]
    v_cvt_pk_bf16_f32 v163, v242, v243
    s_waitcnt lgkmcnt(6)
    v_lshlrev_b32 v240, 16, v164
    v_and_b32 v241, 0xffff0000, v164
    v_pk_mul_f32 v[240:241], v[240:241], s[46:47]
    v_cvt_pk_bf16_f32 v164, v240, v241
    ds_read_b128 a[24:27], v202 offset:25600
    ds_read_b128 a[28:31], v203 offset:25600
    v_lshlrev_b32 v242, 16, v165
    v_and_b32 v243, 0xffff0000, v165
    v_pk_mul_f32 v[242:243], v[242:243], s[46:47]
    v_cvt_pk_bf16_f32 v165, v242, v243
    v_lshlrev_b32 v240, 16, v166
    v_and_b32 v241, 0xffff0000, v166
    v_pk_mul_f32 v[240:241], v[240:241], s[46:47]
    v_cvt_pk_bf16_f32 v166, v240, v241
    v_lshlrev_b32 v242, 16, v167
    v_and_b32 v243, 0xffff0000, v167
    v_pk_mul_f32 v[242:243], v[242:243], s[46:47]
    v_cvt_pk_bf16_f32 v167, v242, v243
    s_waitcnt vmcnt(4) lgkmcnt(0)
    s_add_u32 m0, s29, 40960
    v_mfma_f32_16x16x32_bf16 v[128:131], a[0:3], v[152:155], 0
    s_mov_b32 s14, 0
    ds_read_b128 v[168:171], v217 offset:4224
    v_mfma_f32_16x16x32_bf16 v[128:131], a[4:7], v[156:159], v[128:131]
    s_mov_b32 s36, s37
    buffer_load_dwordx4 v212, s[20:23], s31 offen offset:0  lds
    v_mfma_f32_16x16x32_bf16 v[128:131], a[8:11], v[160:163], v[128:131]
    s_mov_b32 s82, s71
    ds_read_b128 v[172:175], v218 offset:4224
    v_mfma_f32_16x16x32_bf16 v[128:131], a[12:15], v[164:167], v[128:131]
    buffer_load_dwordx4 v213, s[20:23], s31 offen offset:1024  lds
    v_mfma_f32_16x16x32_bf16 v[132:135], a[16:19], v[152:155], 0
    s_add_u32 m0, s29, 0
    ds_read_b128 v[176:179], v219 offset:4224
    v_mfma_f32_16x16x32_bf16 v[132:135], a[20:23], v[156:159], v[132:135]
    buffer_load_dwordx4 v214, s[16:19], s32 offen offset:0  lds
    v_mfma_f32_16x16x32_bf16 v[132:135], a[24:27], v[160:163], v[132:135]
    ds_read_b128 v[180:183], v220 offset:4224
    v_mfma_f32_16x16x32_bf16 v[132:135], a[28:31], v[164:167], v[132:135]
    buffer_load_dwordx4 v215, s[16:19], s32 offen offset:1024  lds
    s_mov_b32 s31, s32
    v_exp_f32 v128, v128
    s_mov_b32 s22, s18
    v_exp_f32 v129, v129
    s_sub_u32 s32, s32, 131072
    v_exp_f32 v130, v130
    s_cmp_eq_u32 s32, s33
    v_exp_f32 v131, v131
    s_cselect_b32 s18, s34, s18
    v_exp_f32 v132, v132
    s_cselect_b64 s[32:33], s[80:81], s[32:33]
    v_exp_f32 v133, v133
    v_exp_f32 v134, v134
    v_exp_f32 v135, v135
    v_cvt_pk_bf16_f32 v144, v128, v129
    v_cvt_pk_bf16_f32 v145, v130, v131
    v_cvt_pk_bf16_f32 v146, v132, v133
    v_cvt_pk_bf16_f32 v147, v134, v135
    s_waitcnt lgkmcnt(3)
    v_lshlrev_b32 v240, 16, v168
    v_and_b32 v241, 0xffff0000, v168
    v_pk_mul_f32 v[240:241], v[240:241], s[46:47]
    v_cvt_pk_bf16_f32 v168, v240, v241
    v_lshlrev_b32 v242, 16, v169
    v_and_b32 v243, 0xffff0000, v169
    v_pk_mul_f32 v[242:243], v[242:243], s[46:47]
    v_cvt_pk_bf16_f32 v169, v242, v243
    v_lshlrev_b32 v240, 16, v170
    v_and_b32 v241, 0xffff0000, v170
    v_pk_mul_f32 v[240:241], v[240:241], s[46:47]
    v_cvt_pk_bf16_f32 v170, v240, v241
    s_add_u32 m0, s29, 49152
    s_nop 0
    buffer_load_dwordx4 v212, s[20:23], s31 offen offset:0  lds
    v_lshlrev_b32 v242, 16, v171
    v_and_b32 v243, 0xffff0000, v171
    v_pk_mul_f32 v[242:243], v[242:243], s[46:47]
    v_cvt_pk_bf16_f32 v171, v242, v243
    s_waitcnt lgkmcnt(2)
    v_lshlrev_b32 v240, 16, v172
    v_and_b32 v241, 0xffff0000, v172
    v_pk_mul_f32 v[240:241], v[240:241], s[46:47]
    v_cvt_pk_bf16_f32 v172, v240, v241
    v_lshlrev_b32 v242, 16, v173
    v_and_b32 v243, 0xffff0000, v173
    v_pk_mul_f32 v[242:243], v[242:243], s[46:47]
    v_cvt_pk_bf16_f32 v173, v242, v243
    buffer_load_dwordx4 v213, s[20:23], s31 offen offset:1024  lds
    v_lshlrev_b32 v240, 16, v174
    v_and_b32 v241, 0xffff0000, v174
    v_pk_mul_f32 v[240:241], v[240:241], s[46:47]
    v_cvt_pk_bf16_f32 v174, v240, v241
    v_lshlrev_b32 v242, 16, v175
    v_and_b32 v243, 0xffff0000, v175
    v_pk_mul_f32 v[242:243], v[242:243], s[46:47]
    v_cvt_pk_bf16_f32 v175, v242, v243
    s_waitcnt lgkmcnt(1)
    v_lshlrev_b32 v240, 16, v176
    v_and_b32 v241, 0xffff0000, v176
    v_pk_mul_f32 v[240:241], v[240:241], s[46:47]
    v_cvt_pk_bf16_f32 v176, v240, v241
    s_add_u32 m0, s29, 8192
    s_nop 0
    buffer_load_dwordx4 v214, s[16:19], s32 offen offset:0  lds
    v_lshlrev_b32 v242, 16, v177
    v_and_b32 v243, 0xffff0000, v177
    v_pk_mul_f32 v[242:243], v[242:243], s[46:47]
    v_cvt_pk_bf16_f32 v177, v242, v243
    v_lshlrev_b32 v240, 16, v178
    v_and_b32 v241, 0xffff0000, v178
    v_pk_mul_f32 v[240:241], v[240:241], s[46:47]
    v_cvt_pk_bf16_f32 v178, v240, v241
    v_lshlrev_b32 v242, 16, v179
    v_and_b32 v243, 0xffff0000, v179
    v_pk_mul_f32 v[242:243], v[242:243], s[46:47]
    v_cvt_pk_bf16_f32 v179, v242, v243
    buffer_load_dwordx4 v215, s[16:19], s32 offen offset:1024  lds
    s_waitcnt lgkmcnt(0)
    v_lshlrev_b32 v240, 16, v180
    v_and_b32 v241, 0xffff0000, v180
    v_pk_mul_f32 v[240:241], v[240:241], s[46:47]
    v_cvt_pk_bf16_f32 v180, v240, v241
    v_lshlrev_b32 v242, 16, v181
    v_and_b32 v243, 0xffff0000, v181
    v_pk_mul_f32 v[242:243], v[242:243], s[46:47]
    v_cvt_pk_bf16_f32 v181, v242, v243
    v_lshlrev_b32 v240, 16, v182
    v_and_b32 v241, 0xffff0000, v182
    v_pk_mul_f32 v[240:241], v[240:241], s[46:47]
    v_cvt_pk_bf16_f32 v182, v240, v241
    v_lshlrev_b32 v242, 16, v183
    v_and_b32 v243, 0xffff0000, v183
    v_pk_mul_f32 v[242:243], v[242:243], s[46:47]
    v_cvt_pk_bf16_f32 v183, v242, v243
    s_mov_b32 s31, s32
    s_mov_b32 s22, s18
    s_sub_u32 s32, s32, 131072
    s_cmp_eq_u32 s32, s33
    s_cselect_b32 s18, s34, s18
    s_cselect_b64 s[32:33], s[80:81], s[32:33]
    s_cmp_lt_i32 s89, 0
    s_cselect_b32 s35, s83, s35
    s_cselect_b32 s36, s30, s36
    s_cselect_b32 s14, s87, s14
    s_cmp_ge_i32 s86, s88
    s_cbranch_scc0 L_xarf2
    s_mov_b32 s56, s85
L_xalf2:
    s_mov_b32 m0, s36
    s_sub_u32 s56, s56, 1
    buffer_load_dwordx4 v216, s[12:15], s35 offen offset:0 nt lds
    s_add_u32 s35, s35, 16384
    s_add_u32 s36, s36, 1056
    s_min_u32 s36, s36, s37
    s_cmp_lg_u32 s56, 0
    s_cbranch_scc1 L_xalf2
L_xarf2:
    s_sub_u32 s38, s88, 1
    s_min_i32 s88, s38, s86
    s_max_i32 s88, s88, 0
    s_cmp_lg_u64 vcc, 0
    s_cselect_b32 s88, s38, s88
    s_sub_u32 s38, s38, s88
    s_waitcnt vmcnt(8)
    s_barrier
    v_mfma_f32_16x16x32_bf16 v[136:139], a[0:3], v[168:171], 0
    s_mov_b32 m0, s36
    ds_read_b64_tr_b16 a[32:33], v204 offset:32768
    ds_read_b64_tr_b16 a[34:35], v204 offset:33792
    v_mfma_f32_16x16x32_bf16 v[136:139], a[4:7], v[172:175], v[136:139]
    s_add_u32 s36, s36, 1056
    ds_read_b64_tr_b16 a[36:37], v205 offset:32768
    ds_read_b64_tr_b16 a[38:39], v205 offset:33792
    buffer_load_dwordx4 v216, s[12:15], s35 offen offset:0 nt lds
    v_mfma_f32_16x16x32_bf16 v[136:139], a[8:11], v[176:179], v[136:139]
    s_add_u32 s35, s35, 16384
    ds_read_b64_tr_b16 a[40:41], v206 offset:32768
    ds_read_b64_tr_b16 a[42:43], v206 offset:33792
    v_mfma_f32_16x16x32_bf16 v[136:139], a[12:15], v[180:183], v[136:139]
    s_min_u32 s36, s36, s37
    ds_read_b64_tr_b16 a[44:45], v207 offset:32768
    ds_read_b64_tr_b16 a[46:47], v207 offset:33792
    v_mfma_f32_16x16x32_bf16 v[140:143], a[16:19], v[168:171], 0
    s_mov_b32 m0, s36
    ds_read_b64_tr_b16 a[48:49], v208 offset:32768
    ds_read_b64_tr_b16 a[50:51], v208 offset:33792
    v_mfma_f32_16x16x32_bf16 v[140:143], a[20:23], v[172:175], v[140:143]
    s_add_u32 s36, s36, 1056
    ds_read_b64_tr_b16 a[52:53], v209 offset:32768
    ds_read_b64_tr_b16 a[54:55], v209 offset:33792
    buffer_load_dwordx4 v216, s[12:15], s35 offen offset:0 nt lds
    v_mfma_f32_16x16x32_bf16 v[140:143], a[24:27], v[176:179], v[140:143]
    s_add_u32 s35, s35, 16384
    ds_read_b64_tr_b16 a[56:57], v210 offset:32768
    ds_read_b64_tr_b16 a[58:59], v210 offset:33792
    v_mfma_f32_16x16x32_bf16 v[140:143], a[28:31], v[180:183], v[140:143]
    s_min_u32 s36, s36, s37
    ds_read_b64_tr_b16 a[60:61], v211 offset:32768
    ds_read_b64_tr_b16 a[62:63], v211 offset:33792
    s_add_u32 m0, s29, 57344
    s_nop 0
    buffer_load_dwordx4 v212, s[20:23], s31 offen offset:0  lds
    buffer_load_dwordx4 v213, s[20:23], s31 offen offset:1024  lds
    s_add_u32 m0, s29, 16384
    s_mov_b32 s22, s18
    buffer_load_dwordx4 v214, s[16:19], s32 offen offset:0  lds
    buffer_load_dwordx4 v215, s[16:19], s32 offen offset:1024  lds
    s_mov_b32 s31, s32
    s_sub_u32 s32, s32, 131072
    s_cmp_eq_u32 s32, s33
    s_cselect_b32 s18, s34, s18
    s_cselect_b64 s[32:33], s[80:81], s[32:33]
L_body2_0:
    v_mfma_f32_16x16x32_bf16 a[88:91], a[104:107], v[144:147], a[88:91]
    s_waitcnt lgkmcnt(3)
    v_exp_f32 v136, v136
    v_mfma_f32_16x16x32_bf16 v[0:3], a[32:35], v[144:147], v[0:3]
    s_mov_b32 m0, s36
    ds_read_b128 a[0:3], v200 offset:32768
    ds_read_b128 a[4:7], v201 offset:32768
    v_mfma_f32_16x16x32_bf16 v[4:7], a[36:39], v[144:147], v[4:7]
    ds_read_b128 a[8:11], v202 offset:32768
    buffer_load_dwordx4 v216, s[12:15], s35 offen offset:0 nt lds
    v_mfma_f32_16x16x32_bf16 v[8:11], a[40:43], v[144:147], v[8:11]
    s_add_u32 m0, s29, 65536
    ds_read_b128 a[12:15], v203 offset:32768
    v_exp_f32 v137, v137
    v_mfma_f32_16x16x32_bf16 v[12:15], a[44:47], v[144:147], v[12:15]
    s_mov_b32 s39, 8192
    ds_read_b128 a[16:19], v200 offset:33792
    buffer_load_dwordx4 v212, s[20:23], s31 offen offset:0  lds
    v_mfma_f32_16x16x32_bf16 v[16:19], a[48:51], v[144:147], v[16:19]
    s_mov_b32 s42, 0
    v_exp_f32 v138, v138
    v_mfma_f32_16x16x32_bf16 v[20:23], a[52:55], v[144:147], v[20:23]
    s_waitcnt lgkmcnt(3)
    ds_read_b128 a[20:23], v201 offset:33792
    v_cvt_pk_bf16_f32 v148, v136, v137
    v_mfma_f32_16x16x32_bf16 v[24:27], a[56:59], v[144:147], v[24:27]
    s_mov_b32 s43, 32768
    v_exp_f32 v139, v139
    v_mfma_f32_16x16x32_bf16 v[28:31], a[60:63], v[144:147], v[28:31]
    ds_read_b128 a[24:27], v202 offset:33792
    v_cvt_pk_bf16_f32 v149, v138, v139
    v_mfma_f32_16x16x32_bf16 v[128:131], a[0:3], v[152:155], 0
    v_exp_f32 v140, v140
    v_mfma_f32_16x16x32_bf16 v[128:131], a[4:7], v[156:159], v[128:131]
    s_waitcnt lgkmcnt(2)
    v_exp_f32 v141, v141
    v_mfma_f32_16x16x32_bf16 v[128:131], a[8:11], v[160:163], v[128:131]
    buffer_load_dwordx4 v213, s[20:23], s31 offen offset:1024  lds
    ds_read_b128 a[28:31], v203 offset:33792
    v_mfma_f32_16x16x32_bf16 v[128:131], a[12:15], v[164:167], v[128:131]
    s_add_u32 m0, s29, 24576
    v_exp_f32 v142, v142
    v_mfma_f32_16x16x32_bf16 v[132:135], a[16:19], v[152:155], 0
    s_waitcnt lgkmcnt(1)
    buffer_load_dwordx4 v214, s[16:19], s32 offen offset:0  lds
    v_cvt_pk_bf16_f32 v150, v140, v141
    v_mfma_f32_16x16x32_bf16 v[132:135], a[20:23], v[156:159], v[132:135]
    v_exp_f32 v143, v143
    v_mfma_f32_16x16x32_bf16 v[132:135], a[24:27], v[160:163], v[132:135]
    s_waitcnt lgkmcnt(0)
    buffer_load_dwordx4 v215, s[16:19], s32 offen offset:1024  lds
    v_cvt_pk_bf16_f32 v151, v142, v143
    v_mfma_f32_16x16x32_bf16 v[132:135], a[28:31], v[164:167], v[132:135]
    s_waitcnt vmcnt(15)
    v_exp_f32 v128, v128
    v_mfma_f32_16x16x32_bf16 v[32:35], a[32:35], v[148:151], v[32:35]
    s_barrier
    ds_read_b64_tr_b16 a[32:33], v204 offset:0
    v_mfma_f32_16x16x32_bf16 v[36:39], a[36:39], v[148:151], v[36:39]
    s_add_u32 s35, s35, 16384
    ds_read_b64_tr_b16 a[34:35], v204 offset:1024
    v_exp_f32 v129, v129
    v_mfma_f32_16x16x32_bf16 v[40:43], a[40:43], v[148:151], v[40:43]
    s_add_u32 s36, s36, 1056
    ds_read_b64_tr_b16 a[36:37], v205 offset:0
    v_cvt_pk_bf16_f32 v144, v128, v129
    v_mfma_f32_16x16x32_bf16 v[44:47], a[44:47], v[148:151], v[44:47]
    s_min_u32 s36, s36, s37
    ds_read_b64_tr_b16 a[38:39], v205 offset:1024
    ds_read_b64_tr_b16 a[40:41], v206 offset:0
    v_mfma_f32_16x16x32_bf16 v[48:51], a[48:51], v[148:151], v[48:51]
    s_sub_u32 s89, s89, 1
    ds_read_b64_tr_b16 a[42:43], v206 offset:1024
    ds_read_b64_tr_b16 a[44:45], v207 offset:0
    v_mfma_f32_16x16x32_bf16 v[52:55], a[52:55], v[148:151], v[52:55]
    s_cselect_b32 s35, s83, s35
    v_exp_f32 v130, v130
    v_mfma_f32_16x16x32_bf16 v[56:59], a[56:59], v[148:151], v[56:59]
    s_cselect_b32 s36, s30, s36
    v_exp_f32 v131, v131
    v_mfma_f32_16x16x32_bf16 v[60:63], a[60:63], v[148:151], v[60:63]
    v_exp_f32 v132, v132
    v_mfma_f32_16x16x32_bf16 a[92:95], a[104:107], v[148:151], a[92:95]
    s_cselect_b32 s14, s87, s14
    ds_read_b64_tr_b16 a[46:47], v207 offset:1024
    v_cvt_pk_bf16_f32 v145, v130, v131
    v_mfma_f32_16x16x32_bf16 v[136:139], a[0:3], v[168:171], 0
    s_mov_b32 s31, s32
    ds_read_b64_tr_b16 a[48:49], v208 offset:0
    ds_read_b64_tr_b16 a[50:51], v208 offset:1024
    v_mfma_f32_16x16x32_bf16 v[136:139], a[4:7], v[172:175], v[136:139]
    s_mov_b32 s22, s18
    v_exp_f32 v133, v133
    v_mfma_f32_16x16x32_bf16 v[136:139], a[8:11], v[176:179], v[136:139]
    s_sub_u32 s32, s32, 131072
    ds_read_b64_tr_b16 a[52:53], v209 offset:0
    v_cvt_pk_bf16_f32 v146, v132, v133
    v_mfma_f32_16x16x32_bf16 v[136:139], a[12:15], v[180:183], v[136:139]
    ds_read_b64_tr_b16 a[54:55], v209 offset:1024
    ds_read_b64_tr_b16 a[56:57], v210 offset:0
    v_mfma_f32_16x16x32_bf16 v[140:143], a[16:19], v[168:171], 0
    s_cmp_eq_u32 s32, s33
    v_exp_f32 v134, v134
    v_mfma_f32_16x16x32_bf16 v[140:143], a[20:23], v[172:175], v[140:143]
    s_cselect_b32 s18, s34, s18
    v_exp_f32 v135, v135
    v_mfma_f32_16x16x32_bf16 v[140:143], a[24:27], v[176:179], v[140:143]
    s_cselect_b64 s[32:33], s[80:81], s[32:33]
    ds_read_b64_tr_b16 a[58:59], v210 offset:1024
    v_cvt_pk_bf16_f32 v147, v134, v135
    v_mfma_f32_16x16x32_bf16 v[140:143], a[28:31], v[180:183], v[140:143]
    s_sub_u32 s38, s38, 1
    ds_read_b64_tr_b16 a[60:61], v211 offset:0
    ds_read_b64_tr_b16 a[62:63], v211 offset:1024
    s_cbranch_scc1 L_ex2
L_body2_1:
    v_mfma_f32_16x16x32_bf16 a[88:91], a[104:107], v[144:147], a[88:91]
    s_waitcnt lgkmcnt(3)
    v_exp_f32 v136, v136
    v_mfma_f32_16x16x32_bf16 v[0:3], a[32:35], v[144:147], v[0:3]
    s_mov_b32 m0, s36
    ds_read_b128 a[0:3], v200 offset:0
    ds_read_b128 a[4:7], v201 offset:0
    v_mfma_f32_16x16x32_bf16 v[4:7], a[36:39], v[144:147], v[4:7]
    ds_read_b128 a[8:11], v202 offset:0
    buffer_load_dwordx4 v216, s[12:15], s35 offen offset:0 nt lds
    v_mfma_f32_16x16x32_bf16 v[8:11], a[40:43], v[144:147], v[8:11]
    s_add_u32 m0, s29, 73728
    ds_read_b128 a[12:15], v203 offset:0
    v_exp_f32 v137, v137
    v_mfma_f32_16x16x32_bf16 v[12:15], a[44:47], v[144:147], v[12:15]
    s_mov_b32 s39, 16384
    ds_read_b128 a[16:19], v200 offset:1024
    buffer_load_dwordx4 v212, s[20:23], s31 offen offset:0  lds
    v_mfma_f32_16x16x32_bf16 v[16:19], a[48:51], v[144:147], v[16:19]
    s_mov_b32 s42, 8192
    v_exp_f32 v138, v138
    v_mfma_f32_16x16x32_bf16 v[20:23], a[52:55], v[144:147], v[20:23]
    s_waitcnt lgkmcnt(3)
    ds_read_b128 a[20:23], v201 offset:1024
    v_cvt_pk_bf16_f32 v148, v136, v137
    v_mfma_f32_16x16x32_bf16 v[24:27], a[56:59], v[144:147], v[24:27]
    s_mov_b32 s43, 0
    v_exp_f32 v139, v139
    v_mfma_f32_16x16x32_bf16 v[28:31], a[60:63], v[144:147], v[28:31]
    ds_read_b128 a[24:27], v202 offset:1024
    v_cvt_pk_bf16_f32 v149, v138, v139
    v_mfma_f32_16x16x32_bf16 v[128:131], a[0:3], v[152:155], 0
    v_exp_f32 v140, v140
    v_mfma_f32_16x16x32_bf16 v[128:131], a[4:7], v[156:159], v[128:131]
    s_waitcnt lgkmcnt(2)
    v_exp_f32 v141, v141
    v_mfma_f32_16x16x32_bf16 v[128:131], a[8:11], v[160:163], v[128:131]
    buffer_load_dwordx4 v213, s[20:23], s31 offen offset:1024  lds
    ds_read_b128 a[28:31], v203 offset:1024
    v_mfma_f32_16x16x32_bf16 v[128:131], a[12:15], v[164:167], v[128:131]
    s_add_u32 m0, s29, 32768
    v_exp_f32 v142, v142
    v_mfma_f32_16x16x32_bf16 v[132:135], a[16:19], v[152:155], 0
    s_waitcnt lgkmcnt(1)
    buffer_load_dwordx4 v214, s[16:19], s32 offen offset:0  lds
    v_cvt_pk_bf16_f32 v150, v140, v141
    v_mfma_f32_16x16x32_bf16 v[132:135], a[20:23], v[156:159], v[132:135]
    v_exp_f32 v143, v143
    v_mfma_f32_16x16x32_bf16 v[132:135], a[24:27], v[160:163], v[132:135]
    s_waitcnt lgkmcnt(0)
    buffer_load_dwordx4 v215, s[16:19], s32 offen offset:1024  lds
    v_cvt_pk_bf16_f32 v151, v142, v143
    v_mfma_f32_16x16x32_bf16 v[132:135], a[28:31], v[164:167], v[132:135]
    s_waitcnt vmcnt(15)
    v_exp_f32 v128, v128
    v_mfma_f32_16x16x32_bf16 v[32:35], a[32:35], v[148:151], v[32:35]
    s_barrier
    ds_read_b64_tr_b16 a[32:33], v204 offset:8192
    v_mfma_f32_16x16x32_bf16 v[36:39], a[36:39], v[148:151], v[36:39]
    s_add_u32 s35, s35, 16384
    ds_read_b64_tr_b16 a[34:35], v204 offset:9216
    v_exp_f32 v129, v129
    v_mfma_f32_16x16x32_bf16 v[40:43], a[40:43], v[148:151], v[40:43]
    s_add_u32 s36, s36, 1056
    ds_read_b64_tr_b16 a[36:37], v205 offset:8192
    v_cvt_pk_bf16_f32 v144, v128, v129
    v_mfma_f32_16x16x32_bf16 v[44:47], a[44:47], v[148:151], v[44:47]
    s_min_u32 s36, s36, s37
    ds_read_b64_tr_b16 a[38:39], v205 offset:9216
    ds_read_b64_tr_b16 a[40:41], v206 offset:8192
    v_mfma_f32_16x16x32_bf16 v[48:51], a[48:51], v[148:151], v[48:51]
    s_sub_u32 s89, s89, 1
    ds_read_b64_tr_b16 a[42:43], v206 offset:9216
    ds_read_b64_tr_b16 a[44:45], v207 offset:8192
    v_mfma_f32_16x16x32_bf16 v[52:55], a[52:55], v[148:151], v[52:55]
    s_cselect_b32 s35, s83, s35
    v_exp_f32 v130, v130
    v_mfma_f32_16x16x32_bf16 v[56:59], a[56:59], v[148:151], v[56:59]
    s_cselect_b32 s36, s30, s36
    v_exp_f32 v131, v131
    v_mfma_f32_16x16x32_bf16 v[60:63], a[60:63], v[148:151], v[60:63]
    v_exp_f32 v132, v132
    v_mfma_f32_16x16x32_bf16 a[92:95], a[104:107], v[148:151], a[92:95]
    s_cselect_b32 s14, s87, s14
    ds_read_b64_tr_b16 a[46:47], v207 offset:9216
    v_cvt_pk_bf16_f32 v145, v130, v131
    v_mfma_f32_16x16x32_bf16 v[136:139], a[0:3], v[168:171], 0
    s_mov_b32 s31, s32
    ds_read_b64_tr_b16 a[48:49], v208 offset:8192
    ds_read_b64_tr_b16 a[50:51], v208 offset:9216
    v_mfma_f32_16x16x32_bf16 v[136:139], a[4:7], v[172:175], v[136:139]
    s_mov_b32 s22, s18
    v_exp_f32 v133, v133
    v_mfma_f32_16x16x32_bf16 v[136:139], a[8:11], v[176:179], v[136:139]
    s_sub_u32 s32, s32, 131072
    ds_read_b64_tr_b16 a[52:53], v209 offset:8192
    v_cvt_pk_bf16_f32 v146, v132, v133
    v_mfma_f32_16x16x32_bf16 v[136:139], a[12:15], v[180:183], v[136:139]
    ds_read_b64_tr_b16 a[54:55], v209 offset:9216
    ds_read_b64_tr_b16 a[56:57], v210 offset:8192
    v_mfma_f32_16x16x32_bf16 v[140:143], a[16:19], v[168:171], 0
    s_cmp_eq_u32 s32, s33
    v_exp_f32 v134, v134
    v_mfma_f32_16x16x32_bf16 v[140:143], a[20:23], v[172:175], v[140:143]
    s_cselect_b32 s18, s34, s18
    v_exp_f32 v135, v135
    v_mfma_f32_16x16x32_bf16 v[140:143], a[24:27], v[176:179], v[140:143]
    s_cselect_b64 s[32:33], s[80:81], s[32:33]
    ds_read_b64_tr_b16 a[58:59], v210 offset:9216
    v_cvt_pk_bf16_f32 v147, v134, v135
    v_mfma_f32_16x16x32_bf16 v[140:143], a[28:31], v[180:183], v[140:143]
    s_sub_u32 s38, s38, 1
    ds_read_b64_tr_b16 a[60:61], v211 offset:8192
    ds_read_b64_tr_b16 a[62:63], v211 offset:9216
    s_cbranch_scc1 L_ex2
L_body2_2:
    v_mfma_f32_16x16x32_bf16 a[88:91], a[104:107], v[144:147], a[88:91]
    s_waitcnt lgkmcnt(3)
    v_exp_f32 v136, v136
    v_mfma_f32_16x16x32_bf16 v[0:3], a[32:35], v[144:147], v[0:3]
    s_mov_b32 m0, s36
    ds_read_b128 a[0:3], v200 offset:8192
    ds_read_b128 a[4:7], v201 offset:8192
    v_mfma_f32_16x16x32_bf16 v[4:7], a[36:39], v[144:147], v[4:7]
    ds_read_b128 a[8:11], v202 offset:8192
    buffer_load_dwordx4 v216, s[12:15], s35 offen offset:0 nt lds
    v_mfma_f32_16x16x32_bf16 v[8:11], a[40:43], v[144:147], v[8:11]
    s_add_u32 m0, s29, 40960
    ds_read_b128 a[12:15], v203 offset:8192
    v_exp_f32 v137, v137
    v_mfma_f32_16x16x32_bf16 v[12:15], a[44:47], v[144:147], v[12:15]
    s_mov_b32 s39, 24576
    ds_read_b128 a[16:19], v200 offset:9216
    buffer_load_dwordx4 v212, s[20:23], s31 offen offset:0  lds
    v_mfma_f32_16x16x32_bf16 v[16:19], a[48:51], v[144:147], v[16:19]
    s_mov_b32 s42, 16384
    v_exp_f32 v138, v138
    v_mfma_f32_16x16x32_bf16 v[20:23], a[52:55], v[144:147], v[20:23]
    s_waitcnt lgkmcnt(3)
    ds_read_b128 a[20:23], v201 offset:9216
    v_cvt_pk_bf16_f32 v148, v136, v137
    v_mfma_f32_16x16x32_bf16 v[24:27], a[56:59], v[144:147], v[24:27]
    s_mov_b32 s43, 8192
    v_exp_f32 v139, v139
    v_mfma_f32_16x16x32_bf16 v[28:31], a[60:63], v[144:147], v[28:31]
    ds_read_b128 a[24:27], v202 offset:9216
    v_cvt_pk_bf16_f32 v149, v138, v139
    v_mfma_f32_16x16x32_bf16 v[128:131], a[0:3], v[152:155], 0
    v_exp_f32 v140, v140
    v_mfma_f32_16x16x32_bf16 v[128:131], a[4:7], v[156:159], v[128:131]
    s_waitcnt lgkmcnt(2)
    v_exp_f32 v141, v141
    v_mfma_f32_16x16x32_bf16 v[128:131], a[8:11], v[160:163], v[128:131]
    buffer_load_dwordx4 v213, s[20:23], s31 offen offset:1024  lds
    ds_read_b128 a[28:31], v203 offset:9216
    v_mfma_f32_16x16x32_bf16 v[128:131], a[12:15], v[164:167], v[128:131]
    s_add_u32 m0, s29, 0
    v_exp_f32 v142, v142
    v_mfma_f32_16x16x32_bf16 v[132:135], a[16:19], v[152:155], 0
    s_waitcnt lgkmcnt(1)
    buffer_load_dwordx4 v214, s[16:19], s32 offen offset:0  lds
    v_cvt_pk_bf16_f32 v150, v140, v141
    v_mfma_f32_16x16x32_bf16 v[132:135], a[20:23], v[156:159], v[132:135]
    v_exp_f32 v143, v143
    v_mfma_f32_16x16x32_bf16 v[132:135], a[24:27], v[160:163], v[132:135]
    s_waitcnt lgkmcnt(0)
    buffer_load_dwordx4 v215, s[16:19], s32 offen offset:1024  lds
    v_cvt_pk_bf16_f32 v151, v142, v143
    v_mfma_f32_16x16x32_bf16 v[132:135], a[28:31], v[164:167], v[132:135]
    s_waitcnt vmcnt(15)
    v_exp_f32 v128, v128
    v_mfma_f32_16x16x32_bf16 v[32:35], a[32:35], v[148:151], v[32:35]
    s_barrier
    ds_read_b64_tr_b16 a[32:33], v204 offset:16384
    v_mfma_f32_16x16x32_bf16 v[36:39], a[36:39], v[148:151], v[36:39]
    s_add_u32 s35, s35, 16384
    ds_read_b64_tr_b16 a[34:35], v204 offset:17408
    v_exp_f32 v129, v129
    v_mfma_f32_16x16x32_bf16 v[40:43], a[40:43], v[148:151], v[40:43]
    s_add_u32 s36, s36, 1056
    ds_read_b64_tr_b16 a[36:37], v205 offset:16384
    v_cvt_pk_bf16_f32 v144, v128, v129
    v_mfma_f32_16x16x32_bf16 v[44:47], a[44:47], v[148:151], v[44:47]
    s_min_u32 s36, s36, s37
    ds_read_b64_tr_b16 a[38:39], v205 offset:17408
    ds_read_b64_tr_b16 a[40:41], v206 offset:16384
    v_mfma_f32_16x16x32_bf16 v[48:51], a[48:51], v[148:151], v[48:51]
    s_sub_u32 s89, s89, 1
    ds_read_b64_tr_b16 a[42:43], v206 offset:17408
    ds_read_b64_tr_b16 a[44:45], v207 offset:16384
    v_mfma_f32_16x16x32_bf16 v[52:55], a[52:55], v[148:151], v[52:55]
    s_cselect_b32 s35, s83, s35
    v_exp_f32 v130, v130
    v_mfma_f32_16x16x32_bf16 v[56:59], a[56:59], v[148:151], v[56:59]
    s_cselect_b32 s36, s30, s36
    v_exp_f32 v131, v131
    v_mfma_f32_16x16x32_bf16 v[60:63], a[60:63], v[148:151], v[60:63]
    v_exp_f32 v132, v132
    v_mfma_f32_16x16x32_bf16 a[92:95], a[104:107], v[148:151], a[92:95]
    s_cselect_b32 s14, s87, s14
    ds_read_b64_tr_b16 a[46:47], v207 offset:17408
    v_cvt_pk_bf16_f32 v145, v130, v131
    v_mfma_f32_16x16x32_bf16 v[136:139], a[0:3], v[168:171], 0
    s_mov_b32 s31, s32
    ds_read_b64_tr_b16 a[48:49], v208 offset:16384
    ds_read_b64_tr_b16 a[50:51], v208 offset:17408
    v_mfma_f32_16x16x32_bf16 v[136:139], a[4:7], v[172:175], v[136:139]
    s_mov_b32 s22, s18
    v_exp_f32 v133, v133
    v_mfma_f32_16x16x32_bf16 v[136:139], a[8:11], v[176:179], v[136:139]
    s_sub_u32 s32, s32, 131072
    ds_read_b64_tr_b16 a[52:53], v209 offset:16384
    v_cvt_pk_bf16_f32 v146, v132, v133
    v_mfma_f32_16x16x32_bf16 v[136:139], a[12:15], v[180:183], v[136:139]
    ds_read_b64_tr_b16 a[54:55], v209 offset:17408
    ds_read_b64_tr_b16 a[56:57], v210 offset:16384
    v_mfma_f32_16x16x32_bf16 v[140:143], a[16:19], v[168:171], 0
    s_cmp_eq_u32 s32, s33
    v_exp_f32 v134, v134
    v_mfma_f32_16x16x32_bf16 v[140:143], a[20:23], v[172:175], v[140:143]
    s_cselect_b32 s18, s34, s18
    v_exp_f32 v135, v135
    v_mfma_f32_16x16x32_bf16 v[140:143], a[24:27], v[176:179], v[140:143]
    s_cselect_b64 s[32:33], s[80:81], s[32:33]
    ds_read_b64_tr_b16 a[58:59], v210 offset:17408
    v_cvt_pk_bf16_f32 v147, v134, v135
    v_mfma_f32_16x16x32_bf16 v[140:143], a[28:31], v[180:183], v[140:143]
    s_sub_u32 s38, s38, 1
    ds_read_b64_tr_b16 a[60:61], v211 offset:16384
    ds_read_b64_tr_b16 a[62:63], v211 offset:17408
    s_cbranch_scc1 L_ex2
L_body2_3:
    v_mfma_f32_16x16x32_bf16 a[88:91], a[104:107], v[144:147], a[88:91]
    s_waitcnt lgkmcnt(3)
    v_exp_f32 v136, v136
    v_mfma_f32_16x16x32_bf16 v[0:3], a[32:35], v[144:147], v[0:3]
    s_mov_b32 m0, s36
    ds_read_b128 a[0:3], v200 offset:16384
    ds_read_b128 a[4:7], v201 offset:16384
    v_mfma_f32_16x16x32_bf16 v[4:7], a[36:39], v[144:147], v[4:7]
    ds_read_b128 a[8:11], v202 offset:16384
    buffer_load_dwordx4 v216, s[12:15], s35 offen offset:0 nt lds
    v_mfma_f32_16x16x32_bf16 v[8:11], a[40:43], v[144:147], v[8:11]
    s_add_u32 m0, s29, 49152
    ds_read_b128 a[12:15], v203 offset:16384
    v_exp_f32 v137, v137
    v_mfma_f32_16x16x32_bf16 v[12:15], a[44:47], v[144:147], v[12:15]
    s_mov_b32 s39, 32768
    ds_read_b128 a[16:19], v200 offset:17408
    buffer_load_dwordx4 v212, s[20:23], s31 offen offset:0  lds
    v_mfma_f32_16x16x32_bf16 v[16:19], a[48:51], v[144:147], v[16:19]
    s_mov_b32 s42, 24576
    v_exp_f32 v138, v138
    v_mfma_f32_16x16x32_bf16 v[20:23], a[52:55], v[144:147], v[20:23]
    s_waitcnt lgkmcnt(3)
    ds_read_b128 a[20:23], v201 offset:17408
    v_cvt_pk_bf16_f32 v148, v136, v137
    v_mfma_f32_16x16x32_bf16 v[24:27], a[56:59], v[144:147], v[24:27]
    s_mov_b32 s43, 16384
    v_exp_f32 v139, v139
    v_mfma_f32_16x16x32_bf16 v[28:31], a[60:63], v[144:147], v[28:31]
    ds_read_b128 a[24:27], v202 offset:17408
    v_cvt_pk_bf16_f32 v149, v138, v139
    v_mfma_f32_16x16x32_bf16 v[128:131], a[0:3], v[152:155], 0
    v_exp_f32 v140, v140
    v_mfma_f32_16x16x32_bf16 v[128:131], a[4:7], v[156:159], v[128:131]
    s_waitcnt lgkmcnt(2)
    v_exp_f32 v141, v141
    v_mfma_f32_16x16x32_bf16 v[128:131], a[8:11], v[160:163], v[128:131]
    buffer_load_dwordx4 v213, s[20:23], s31 offen offset:1024  lds
    ds_read_b128 a[28:31], v203 offset:17408
    v_mfma_f32_16x16x32_bf16 v[128:131], a[12:15], v[164:167], v[128:131]
    s_add_u32 m0, s29, 8192
    v_exp_f32 v142, v142
    v_mfma_f32_16x16x32_bf16 v[132:135], a[16:19], v[152:155], 0
    s_waitcnt lgkmcnt(1)
    buffer_load_dwordx4 v214, s[16:19], s32 offen offset:0  lds
    v_cvt_pk_bf16_f32 v150, v140, v141
    v_mfma_f32_16x16x32_bf16 v[132:135], a[20:23], v[156:159], v[132:135]
    v_exp_f32 v143, v143
    v_mfma_f32_16x16x32_bf16 v[132:135], a[24:27], v[160:163], v[132:135]
    s_waitcnt lgkmcnt(0)
    buffer_load_dwordx4 v215, s[16:19], s32 offen offset:1024  lds
    v_cvt_pk_bf16_f32 v151, v142, v143
    v_mfma_f32_16x16x32_bf16 v[132:135], a[28:31], v[164:167], v[132:135]
    s_waitcnt vmcnt(15)
    v_exp_f32 v128, v128
    v_mfma_f32_16x16x32_bf16 v[32:35], a[32:35], v[148:151], v[32:35]
    s_barrier
    ds_read_b64_tr_b16 a[32:33], v204 offset:24576
    v_mfma_f32_16x16x32_bf16 v[36:39], a[36:39], v[148:151], v[36:39]
    s_add_u32 s35, s35, 16384
    ds_read_b64_tr_b16 a[34:35], v204 offset:25600
    v_exp_f32 v129, v129
    v_mfma_f32_16x16x32_bf16 v[40:43], a[40:43], v[148:151], v[40:43]
    s_add_u32 s36, s36, 1056
    ds_read_b64_tr_b16 a[36:37], v205 offset:24576
    v_cvt_pk_bf16_f32 v144, v128, v129
    v_mfma_f32_16x16x32_bf16 v[44:47], a[44:47], v[148:151], v[44:47]
    s_min_u32 s36, s36, s37
    ds_read_b64_tr_b16 a[38:39], v205 offset:25600
    ds_read_b64_tr_b16 a[40:41], v206 offset:24576
    v_mfma_f32_16x16x32_bf16 v[48:51], a[48:51], v[148:151], v[48:51]
    s_sub_u32 s89, s89, 1
    ds_read_b64_tr_b16 a[42:43], v206 offset:25600
    ds_read_b64_tr_b16 a[44:45], v207 offset:24576
    v_mfma_f32_16x16x32_bf16 v[52:55], a[52:55], v[148:151], v[52:55]
    s_cselect_b32 s35, s83, s35
    v_exp_f32 v130, v130
    v_mfma_f32_16x16x32_bf16 v[56:59], a[56:59], v[148:151], v[56:59]
    s_cselect_b32 s36, s30, s36
    v_exp_f32 v131, v131
    v_mfma_f32_16x16x32_bf16 v[60:63], a[60:63], v[148:151], v[60:63]
    v_exp_f32 v132, v132
    v_mfma_f32_16x16x32_bf16 a[92:95], a[104:107], v[148:151], a[92:95]
    s_cselect_b32 s14, s87, s14
    ds_read_b64_tr_b16 a[46:47], v207 offset:25600
    v_cvt_pk_bf16_f32 v145, v130, v131
    v_mfma_f32_16x16x32_bf16 v[136:139], a[0:3], v[168:171], 0
    s_mov_b32 s31, s32
    ds_read_b64_tr_b16 a[48:49], v208 offset:24576
    ds_read_b64_tr_b16 a[50:51], v208 offset:25600
    v_mfma_f32_16x16x32_bf16 v[136:139], a[4:7], v[172:175], v[136:139]
    s_mov_b32 s22, s18
    v_exp_f32 v133, v133
    v_mfma_f32_16x16x32_bf16 v[136:139], a[8:11], v[176:179], v[136:139]
    s_sub_u32 s32, s32, 131072
    ds_read_b64_tr_b16 a[52:53], v209 offset:24576
    v_cvt_pk_bf16_f32 v146, v132, v133
    v_mfma_f32_16x16x32_bf16 v[136:139], a[12:15], v[180:183], v[136:139]
    ds_read_b64_tr_b16 a[54:55], v209 offset:25600
    ds_read_b64_tr_b16 a[56:57], v210 offset:24576
    v_mfma_f32_16x16x32_bf16 v[140:143], a[16:19], v[168:171], 0
    s_cmp_eq_u32 s32, s33
    v_exp_f32 v134, v134
    v_mfma_f32_16x16x32_bf16 v[140:143], a[20:23], v[172:175], v[140:143]
    s_cselect_b32 s18, s34, s18
    v_exp_f32 v135, v135
    v_mfma_f32_16x16x32_bf16 v[140:143], a[24:27], v[176:179], v[140:143]
    s_cselect_b64 s[32:33], s[80:81], s[32:33]
    ds_read_b64_tr_b16 a[58:59], v210 offset:25600
    v_cvt_pk_bf16_f32 v147, v134, v135
    v_mfma_f32_16x16x32_bf16 v[140:143], a[28:31], v[180:183], v[140:143]
    s_sub_u32 s38, s38, 1
    ds_read_b64_tr_b16 a[60:61], v211 offset:24576
    ds_read_b64_tr_b16 a[62:63], v211 offset:25600
    s_cbranch_scc1 L_ex2
L_body2_4:
    v_mfma_f32_16x16x32_bf16 a[88:91], a[104:107], v[144:147], a[88:91]
    s_waitcnt lgkmcnt(3)
    v_exp_f32 v136, v136
    v_mfma_f32_16x16x32_bf16 v[0:3], a[32:35], v[144:147], v[0:3]
    s_mov_b32 m0, s36
    ds_read_b128 a[0:3], v200 offset:24576
    ds_read_b128 a[4:7], v201 offset:24576
    v_mfma_f32_16x16x32_bf16 v[4:7], a[36:39], v[144:147], v[4:7]
    ds_read_b128 a[8:11], v202 offset:24576
    buffer_load_dwordx4 v216, s[12:15], s35 offen offset:0 nt lds
    v_mfma_f32_16x16x32_bf16 v[8:11], a[40:43], v[144:147], v[8:11]
    s_add_u32 m0, s29, 57344
    ds_read_b128 a[12:15], v203 offset:24576
    v_exp_f32 v137, v137
    v_mfma_f32_16x16x32_bf16 v[12:15], a[44:47], v[144:147], v[12:15]
    s_mov_b32 s39, 0
    ds_read_b128 a[16:19], v200 offset:25600
    buffer_load_dwordx4 v212, s[20:23], s31 offen offset:0  lds
    v_mfma_f32_16x16x32_bf16 v[16:19], a[48:51], v[144:147], v[16:19]
    s_mov_b32 s42, 32768
    v_exp_f32 v138, v138
    v_mfma_f32_16x16x32_bf16 v[20:23], a[52:55], v[144:147], v[20:23]
    s_waitcnt lgkmcnt(3)
    ds_read_b128 a[20:23], v201 offset:25600
    v_cvt_pk_bf16_f32 v148, v136, v137
    v_mfma_f32_16x16x32_bf16 v[24:27], a[56:59], v[144:147], v[24:27]
    s_mov_b32 s43, 24576
    v_exp_f32 v139, v139
    v_mfma_f32_16x16x32_bf16 v[28:31], a[60:63], v[144:147], v[28:31]
    ds_read_b128 a[24:27], v202 offset:25600
    v_cvt_pk_bf16_f32 v149, v138, v139
    v_mfma_f32_16x16x32_bf16 v[128:131], a[0:3], v[152:155], 0
    v_exp_f32 v140, v140
    v_mfma_f32_16x16x32_bf16 v[128:131], a[4:7], v[156:159], v[128:131]
    s_waitcnt lgkmcnt(2)
    v_exp_f32 v141, v141
    v_mfma_f32_16x16x32_bf16 v[128:131], a[8:11], v[160:163], v[128:131]
    buffer_load_dwordx4 v213, s[20:23], s31 offen offset:1024  lds
    ds_read_b128 a[28:31], v203 offset:25600
    v_mfma_f32_16x16x32_bf16 v[128:131], a[12:15], v[164:167], v[128:131]
    s_add_u32 m0, s29, 16384
    v_exp_f32 v142, v142
    v_mfma_f32_16x16x32_bf16 v[132:135], a[16:19], v[152:155], 0
    s_waitcnt lgkmcnt(1)
    buffer_load_dwordx4 v214, s[16:19], s32 offen offset:0  lds
    v_cvt_pk_bf16_f32 v150, v140, v141
    v_mfma_f32_16x16x32_bf16 v[132:135], a[20:23], v[156:159], v[132:135]
    v_exp_f32 v143, v143
    v_mfma_f32_16x16x32_bf16 v[132:135], a[24:27], v[160:163], v[132:135]
    s_waitcnt lgkmcnt(0)
    buffer_load_dwordx4 v215, s[16:19], s32 offen offset:1024  lds
    v_cvt_pk_bf16_f32 v151, v142, v143
    v_mfma_f32_16x16x32_bf16 v[132:135], a[28:31], v[164:167], v[132:135]
    s_waitcnt vmcnt(15)
    v_exp_f32 v128, v128
    v_mfma_f32_16x16x32_bf16 v[32:35], a[32:35], v[148:151], v[32:35]
    s_barrier
    ds_read_b64_tr_b16 a[32:33], v204 offset:32768
    v_mfma_f32_16x16x32_bf16 v[36:39], a[36:39], v[148:151], v[36:39]
    s_add_u32 s35, s35, 16384
    ds_read_b64_tr_b16 a[34:35], v204 offset:33792
    v_exp_f32 v129, v129
    v_mfma_f32_16x16x32_bf16 v[40:43], a[40:43], v[148:151], v[40:43]
    s_add_u32 s36, s36, 1056
    ds_read_b64_tr_b16 a[36:37], v205 offset:32768
    v_cvt_pk_bf16_f32 v144, v128, v129
    v_mfma_f32_16x16x32_bf16 v[44:47], a[44:47], v[148:151], v[44:47]
    s_min_u32 s36, s36, s37
    ds_read_b64_tr_b16 a[38:39], v205 offset:33792
    ds_read_b64_tr_b16 a[40:41], v206 offset:32768
    v_mfma_f32_16x16x32_bf16 v[48:51], a[48:51], v[148:151], v[48:51]
    s_sub_u32 s89, s89, 1
    ds_read_b64_tr_b16 a[42:43], v206 offset:33792
    ds_read_b64_tr_b16 a[44:45], v207 offset:32768
    v_mfma_f32_16x16x32_bf16 v[52:55], a[52:55], v[148:151], v[52:55]
    s_cselect_b32 s35, s83, s35
    v_exp_f32 v130, v130
    v_mfma_f32_16x16x32_bf16 v[56:59], a[56:59], v[148:151], v[56:59]
    s_cselect_b32 s36, s30, s36
    v_exp_f32 v131, v131
    v_mfma_f32_16x16x32_bf16 v[60:63], a[60:63], v[148:151], v[60:63]
    v_exp_f32 v132, v132
    v_mfma_f32_16x16x32_bf16 a[92:95], a[104:107], v[148:151], a[92:95]
    s_cselect_b32 s14, s87, s14
    ds_read_b64_tr_b16 a[46:47], v207 offset:33792
    v_cvt_pk_bf16_f32 v145, v130, v131
    v_mfma_f32_16x16x32_bf16 v[136:139], a[0:3], v[168:171], 0
    s_mov_b32 s31, s32
    ds_read_b64_tr_b16 a[48:49], v208 offset:32768
    ds_read_b64_tr_b16 a[50:51], v208 offset:33792
    v_mfma_f32_16x16x32_bf16 v[136:139], a[4:7], v[172:175], v[136:139]
    s_mov_b32 s22, s18
    v_exp_f32 v133, v133
    v_mfma_f32_16x16x32_bf16 v[136:139], a[8:11], v[176:179], v[136:139]
    s_sub_u32 s32, s32, 131072
    ds_read_b64_tr_b16 a[52:53], v209 offset:32768
    v_cvt_pk_bf16_f32 v146, v132, v133
    v_mfma_f32_16x16x32_bf16 v[136:139], a[12:15], v[180:183], v[136:139]
    ds_read_b64_tr_b16 a[54:55], v209 offset:33792
    ds_read_b64_tr_b16 a[56:57], v210 offset:32768
    v_mfma_f32_16x16x32_bf16 v[140:143], a[16:19], v[168:171], 0
    s_cmp_eq_u32 s32, s33
    v_exp_f32 v134, v134
    v_mfma_f32_16x16x32_bf16 v[140:143], a[20:23], v[172:175], v[140:143]
    s_cselect_b32 s18, s34, s18
    v_exp_f32 v135, v135
    v_mfma_f32_16x16x32_bf16 v[140:143], a[24:27], v[176:179], v[140:143]
    s_cselect_b64 s[32:33], s[80:81], s[32:33]
    ds_read_b64_tr_b16 a[58:59], v210 offset:33792
    v_cvt_pk_bf16_f32 v147, v134, v135
    v_mfma_f32_16x16x32_bf16 v[140:143], a[28:31], v[180:183], v[140:143]
    s_sub_u32 s38, s38, 1
    ds_read_b64_tr_b16 a[60:61], v211 offset:32768
    ds_read_b64_tr_b16 a[62:63], v211 offset:33792
    s_cbranch_scc0 L_body2_0
L_ex2:
    s_cmp_lg_u32 s88, 0
    s_cbranch_scc1 L_ev
L_last2:
    v_mfma_f32_16x16x32_bf16 a[88:91], a[104:107], v[144:147], a[88:91]
    s_waitcnt lgkmcnt(3)
    v_exp_f32 v136, v136
    v_mfma_f32_16x16x32_bf16 v[0:3], a[32:35], v[144:147], v[0:3]
    s_mov_b32 s44, s50
    v_exp_f32 v137, v137
    v_mfma_f32_16x16x32_bf16 v[4:7], a[36:39], v[144:147], v[4:7]
    s_mov_b32 s26, s53
    v_exp_f32 v138, v138
    v_mfma_f32_16x16x32_bf16 v[8:11], a[40:43], v[144:147], v[8:11]
    s_mov_b64 s[48:49], 0
    v_exp_f32 v139, v139
    v_cvt_pk_bf16_f32 v148, v136, v137
    v_mfma_f32_16x16x32_bf16 v[12:15], a[44:47], v[144:147], v[12:15]
    s_add_u32 s58, s43, s29
    v_exp_f32 v140, v140
    v_cvt_pk_bf16_f32 v149, v138, v139
    v_mfma_f32_16x16x32_bf16 v[16:19], a[48:51], v[144:147], v[16:19]
    s_mov_b32 m0, s36
    v_exp_f32 v141, v141
    v_mfma_f32_16x16x32_bf16 v[20:23], a[52:55], v[144:147], v[20:23]
    s_waitcnt lgkmcnt(0)
    v_exp_f32 v142, v142
    v_mfma_f32_16x16x32_bf16 v[24:27], a[56:59], v[144:147], v[24:27]
    v_exp_f32 v143, v143
    v_mfma_f32_16x16x32_bf16 v[28:31], a[60:63], v[144:147], v[28:31]
    s_waitcnt vmcnt(9)
    v_cvt_pk_bf16_f32 v150, v140, v141
    v_cvt_pk_bf16_f32 v151, v142, v143
    s_cmp_eq_u32 s82, 0
    s_cbranch_scc1 L_fin2
L_trans2:
    v_mfma_f32_16x16x32_bf16 v[32:35], a[32:35], v[148:151], v[32:35]
    s_mov_b32 s50, s83
    buffer_load_dwordx4 v216, s[12:15], s35 offen offset:0 nt lds
    v_add_u32 v228, s42, v200
    v_mfma_f32_16x16x32_bf16 v[36:39], a[36:39], v[148:151], v[36:39]
    s_add_u32 m0, s58, 40960
    ds_read_b128 v[152:155], v217 offset:0
    v_add_u32 v229, s42, v201
    v_mfma_f32_16x16x32_bf16 v[40:43], a[40:43], v[148:151], v[40:43]
    s_mov_b32 s53, s87
    buffer_load_dwordx4 v212, s[20:23], s31 offen offset:0  lds
    v_mfma_f32_16x16x32_bf16 v[44:47], a[44:47], v[148:151], v[44:47]
    s_mov_b32 s84, s91
    ds_read_b128 v[156:159], v218 offset:0
    v_add_u32 v230, s42, v202
    v_mfma_f32_16x16x32_bf16 v[48:51], a[48:51], v[148:151], v[48:51]
    s_bfe_u32 s88, s82, 262161
    buffer_load_dwordx4 v213, s[20:23], s31 offen offset:1024  lds
    v_mfma_f32_16x16x32_bf16 v[52:55], a[52:55], v[148:151], v[52:55]
    s_mov_b32 m0, s58
    ds_read_b128 v[160:163], v219 offset:0
    v_add_u32 v231, s42, v203
    v_mfma_f32_16x16x32_bf16 v[56:59], a[56:59], v[148:151], v[56:59]
    s_add_u32 s88, s88, 1
    buffer_load_dwordx4 v214, s[16:19], s32 offen offset:0  lds
    v_mfma_f32_16x16x32_bf16 v[60:63], a[60:63], v[148:151], v[60:63]
    s_bfe_u32 s45, s82, 393237
    ds_read_b128 v[164:167], v220 offset:0
    v_accvgpr_read_b32 v250, a88
    v_mfma_f32_16x16x32_bf16 a[92:95], a[104:107], v[148:151], a[92:95]
    s_bfe_u32 s86, s82, 327683
    buffer_load_dwordx4 v215, s[16:19], s32 offen offset:1024  lds
    v_rcp_f32 v248, v250
    v_subrev_u32 v250, s51, v250
    v_cmp_le_u32 vcc, s52, v250
    v_pk_mul_f32 v[0:1], v[0:1], v[248:249] op_sel_hi:[1,0]
    v_pk_mul_f32 v[2:3], v[2:3], v[248:249] op_sel_hi:[1,0]
    v_pk_mul_f32 v[4:5], v[4:5], v[248:249] op_sel_hi:[1,0]
    v_pk_mul_f32 v[6:7], v[6:7], v[248:249] op_sel_hi:[1,0]
    v_pk_mul_f32 v[8:9], v[8:9], v[248:249] op_sel_hi:[1,0]
    v_pk_mul_f32 v[10:11], v[10:11], v[248:249] op_sel_hi:[1,0]
    v_pk_mul_f32 v[12:13], v[12:13], v[248:249] op_sel_hi:[1,0]
    v_pk_mul_f32 v[14:15], v[14:15], v[248:249] op_sel_hi:[1,0]
    v_pk_mul_f32 v[16:17], v[16:17], v[248:249] op_sel_hi:[1,0]
    v_pk_mul_f32 v[18:19], v[18:19], v[248:249] op_sel_hi:[1,0]
    v_pk_mul_f32 v[20:21], v[20:21], v[248:249] op_sel_hi:[1,0]
    v_pk_mul_f32 v[22:23], v[22:23], v[248:249] op_sel_hi:[1,0]
    v_pk_mul_f32 v[24:25], v[24:25], v[248:249] op_sel_hi:[1,0]
    v_pk_mul_f32 v[26:27], v[26:27], v[248:249] op_sel_hi:[1,0]
    v_pk_mul_f32 v[28:29], v[28:29], v[248:249] op_sel_hi:[1,0]
    v_pk_mul_f32 v[30:31], v[30:31], v[248:249] op_sel_hi:[1,0]
    v_cvt_pk_bf16_f32 v184, v0, v4
    v_cvt_pk_bf16_f32 v185, v8, v12
    v_cvt_pk_bf16_f32 v186, v16, v20
    v_cvt_pk_bf16_f32 v187, v24, v28
    v_cvt_pk_bf16_f32 v188, v1, v5
    v_cvt_pk_bf16_f32 v189, v9, v13
    v_cvt_pk_bf16_f32 v190, v17, v21
    v_cvt_pk_bf16_f32 v191, v25, v29
    v_mfma_f32_16x16x32_bf16 v[128:131], v[184:187], a[64:67], 0
    s_or_b64 s[48:49], s[48:49], vcc
    v_cvt_pk_bf16_f32 v192, v2, v6
    v_cvt_pk_bf16_f32 v193, v10, v14
    v_mfma_f32_16x16x32_bf16 v[144:147], v[184:187], a[68:71], 0
    s_sub_u32 s89, s88, s86
    v_cvt_pk_bf16_f32 v194, v18, v22
    v_cvt_pk_bf16_f32 v195, v26, v30
    v_mfma_f32_16x16x32_bf16 v[132:135], v[188:191], a[64:67], 0
    s_and_b32 s85, s82, 7
    s_cselect_b32 s86, s86, 0
    v_cvt_pk_bf16_f32 v196, v3, v7
    v_cvt_pk_bf16_f32 v197, v11, v15
    v_mfma_f32_16x16x32_bf16 v[148:151], v[188:191], a[68:71], 0
    s_sub_u32 s86, s86, 1
    v_cvt_pk_bf16_f32 v198, v19, v23
    v_cvt_pk_bf16_f32 v199, v27, v31
    v_mfma_f32_16x16x32_bf16 v[136:139], v[192:195], a[64:67], 0
    s_sub_u32 s38, s88, 1
    ds_read_b128 v[168:171], v217 offset:4224
    ds_read_b128 v[172:175], v218 offset:4224
    v_mfma_f32_16x16x32_bf16 v[224:227], v[192:195], a[68:71], 0
    s_min_i32 s88, s38, s86
    ds_read_b128 v[176:179], v219 offset:4224
    ds_read_b128 v[180:183], v220 offset:4224
    v_mfma_f32_16x16x32_bf16 v[140:143], v[196:199], a[64:67], 0
    s_max_i32 s88, s88, 0
    v_cvt_pk_bf16_f32 v0, v128, v132
    v_cvt_pk_bf16_f32 v4, v129, v133
    v_mfma_f32_16x16x32_bf16 v[244:247], v[196:199], a[68:71], 0
    s_sub_u32 s38, s38, s88
    v_cvt_pk_bf16_f32 v8, v130, v134
    v_cvt_pk_bf16_f32 v12, v131, v135
    v_cvt_pk_bf16_f32 v2, v144, v148
    v_cvt_pk_bf16_f32 v6, v145, v149
    v_cvt_pk_bf16_f32 v10, v146, v150
    v_cvt_pk_bf16_f32 v14, v147, v151
    v_cvt_pk_bf16_f32 v1, v136, v140
    v_cvt_pk_bf16_f32 v5, v137, v141
    v_cvt_pk_bf16_f32 v9, v138, v142
    v_cvt_pk_bf16_f32 v13, v139, v143
    v_cvt_pk_bf16_f32 v3, v224, v244
    v_cvt_pk_bf16_f32 v7, v225, v245
    v_cvt_pk_bf16_f32 v11, v226, v246
    v_cvt_pk_bf16_f32 v15, v227, v247
    s_waitcnt lgkmcnt(4)
    buffer_store_dwordx4 v[0:3], v223, s[24:27], s44 offen sc1
    v_lshlrev_b32 v240, 16, v152
    v_and_b32 v241, 0xffff0000, v152
    v_pk_mul_f32 v[240:241], v[240:241], s[46:47]
    v_cvt_pk_bf16_f32 v152, v240, v241
    v_lshlrev_b32 v242, 16, v153
    v_and_b32 v243, 0xffff0000, v153
    v_pk_mul_f32 v[242:243], v[242:243], s[46:47]
    v_cvt_pk_bf16_f32 v153, v242, v243
    v_lshlrev_b32 v240, 16, v154
    v_and_b32 v241, 0xffff0000, v154
    v_pk_mul_f32 v[240:241], v[240:241], s[46:47]
    v_cvt_pk_bf16_f32 v154, v240, v241
    v_lshlrev_b32 v242, 16, v155
    v_and_b32 v243, 0xffff0000, v155
    v_pk_mul_f32 v[242:243], v[242:243], s[46:47]
    v_cvt_pk_bf16_f32 v155, v242, v243
    v_lshlrev_b32 v240, 16, v156
    v_and_b32 v241, 0xffff0000, v156
    v_pk_mul_f32 v[240:241], v[240:241], s[46:47]
    v_cvt_pk_bf16_f32 v156, v240, v241
    v_lshlrev_b32 v242, 16, v157
    v_and_b32 v243, 0xffff0000, v157
    v_pk_mul_f32 v[242:243], v[242:243], s[46:47]
    v_cvt_pk_bf16_f32 v157, v242, v243
    v_lshlrev_b32 v240, 16, v158
    v_and_b32 v241, 0xffff0000, v158
    v_pk_mul_f32 v[240:241], v[240:241], s[46:47]
    v_cvt_pk_bf16_f32 v158, v240, v241
    s_add_u32 s44, s44, 4096
    buffer_store_dwordx4 v[4:7], v223, s[24:27], s44 offen sc1
    v_lshlrev_b32 v242, 16, v159
    v_and_b32 v243, 0xffff0000, v159
    v_pk_mul_f32 v[242:243], v[242:243], s[46:47]
    v_cvt_pk_bf16_f32 v159, v242, v243
    v_lshlrev_b32 v240, 16, v160
    v_and_b32 v241, 0xffff0000, v160
    v_pk_mul_f32 v[240:241], v[240:241], s[46:47]
    v_cvt_pk_bf16_f32 v160, v240, v241
    v_lshlrev_b32 v242, 16, v161
    v_and_b32 v243, 0xffff0000, v161
    v_pk_mul_f32 v[242:243], v[242:243], s[46:47]
    v_cvt_pk_bf16_f32 v161, v242, v243
    v_accvgpr_read_b32 v250, a92
    v_rcp_f32 v248, v250
    v_subrev_u32 v250, s51, v250
    v_cmp_le_u32 vcc, s52, v250
    v_pk_mul_f32 v[32:33], v[32:33], v[248:249] op_sel_hi:[1,0]
    v_pk_mul_f32 v[34:35], v[34:35], v[248:249] op_sel_hi:[1,0]
    v_pk_mul_f32 v[36:37], v[36:37], v[248:249] op_sel_hi:[1,0]
    v_pk_mul_f32 v[38:39], v[38:39], v[248:249] op_sel_hi:[1,0]
    v_pk_mul_f32 v[40:41], v[40:41], v[248:249] op_sel_hi:[1,0]
    v_pk_mul_f32 v[42:43], v[42:43], v[248:249] op_sel_hi:[1,0]
    v_pk_mul_f32 v[44:45], v[44:45], v[248:249] op_sel_hi:[1,0]
    v_pk_mul_f32 v[46:47], v[46:47], v[248:249] op_sel_hi:[1,0]
    v_pk_mul_f32 v[48:49], v[48:49], v[248:249] op_sel_hi:[1,0]
    v_pk_mul_f32 v[50:51], v[50:51], v[248:249] op_sel_hi:[1,0]
    v_pk_mul_f32 v[52:53], v[52:53], v[248:249] op_sel_hi:[1,0]
    v_pk_mul_f32 v[54:55], v[54:55], v[248:249] op_sel_hi:[1,0]
    s_add_u32 s44, s44, 4096
    buffer_store_dwordx4 v[8:11], v223, s[24:27], s44 offen sc1
    v_pk_mul_f32 v[56:57], v[56:57], v[248:249] op_sel_hi:[1,0]
    v_pk_mul_f32 v[58:59], v[58:59], v[248:249] op_sel_hi:[1,0]
    v_pk_mul_f32 v[60:61], v[60:61], v[248:249] op_sel_hi:[1,0]
    v_pk_mul_f32 v[62:63], v[62:63], v[248:249] op_sel_hi:[1,0]
    v_cvt_pk_bf16_f32 v184, v32, v36
    v_cvt_pk_bf16_f32 v185, v40, v44
    v_cvt_pk_bf16_f32 v186, v48, v52
    v_cvt_pk_bf16_f32 v187, v56, v60
    v_cvt_pk_bf16_f32 v188, v33, v37
    v_cvt_pk_bf16_f32 v189, v41, v45
    v_cvt_pk_bf16_f32 v190, v49, v53
    v_cvt_pk_bf16_f32 v191, v57, v61
    v_mfma_f32_16x16x32_bf16 v[128:131], v[184:187], a[64:67], 0
    s_or_b64 s[48:49], s[48:49], vcc
    v_cvt_pk_bf16_f32 v192, v34, v38
    v_cvt_pk_bf16_f32 v193, v42, v46
    v_mfma_f32_16x16x32_bf16 v[144:147], v[184:187], a[68:71], 0
    s_and_b32 s54, s75, 0x1ff00
    v_cvt_pk_bf16_f32 v194, v50, v54
    v_cvt_pk_bf16_f32 v195, v58, v62
    v_mfma_f32_16x16x32_bf16 v[132:135], v[188:191], a[64:67], 0
    s_add_u32 s34, s72, s54
    v_cvt_pk_bf16_f32 v196, v35, v39
    v_cvt_pk_bf16_f32 v197, v43, v47
    v_mfma_f32_16x16x32_bf16 v[148:151], v[188:191], a[68:71], 0
    s_mov_b64 s[80:81], s[72:73]
    v_cvt_pk_bf16_f32 v198, v51, v55
    v_cvt_pk_bf16_f32 v199, v59, v63
    s_add_u32 s44, s44, 4096
    buffer_store_dwordx4 v[12:15], v223, s[24:27], s44 offen sc1
    v_mfma_f32_16x16x32_bf16 v[136:139], v[192:195], a[64:67], 0
    s_bfe_u32 s91, s75, 196637
    ds_read_b128 a[0:3], v228 offset:0
    ds_read_b128 a[4:7], v229 offset:0
    v_mfma_f32_16x16x32_bf16 v[224:227], v[192:195], a[68:71], 0
    s_bfe_u32 s54, s75, 131099
    ds_read_b128 a[8:11], v230 offset:0
    ds_read_b128 a[12:15], v231 offset:0
    v_mfma_f32_16x16x32_bf16 v[140:143], v[196:199], a[64:67], 0
    s_mul_i32 s55, s91, s28
    v_cvt_pk_bf16_f32 v32, v128, v132
    v_cvt_pk_bf16_f32 v36, v129, v133
    v_mfma_f32_16x16x32_bf16 v[244:247], v[196:199], a[68:71], 0
    s_cmp_lt_u32 s28, s54
    s_addc_u32 s91, s91, 0
    v_cvt_pk_bf16_f32 v40, v130, v134
    v_cvt_pk_bf16_f32 v44, v131, v135
    v_cvt_pk_bf16_f32 v34, v144, v148
    v_cvt_pk_bf16_f32 v38, v145, v149
    v_cvt_pk_bf16_f32 v42, v146, v150
    v_cvt_pk_bf16_f32 v46, v147, v151
    v_cvt_pk_bf16_f32 v33, v136, v140
    v_cvt_pk_bf16_f32 v37, v137, v141
    v_cvt_pk_bf16_f32 v41, v138, v142
    v_cvt_pk_bf16_f32 v45, v139, v143
    v_cvt_pk_bf16_f32 v35, v224, v244
    v_cvt_pk_bf16_f32 v39, v225, v245
    v_cvt_pk_bf16_f32 v43, v226, v246
    v_cvt_pk_bf16_f32 v47, v227, v247
    s_add_u32 s44, s44, 53248
    s_waitcnt lgkmcnt(4)
    buffer_store_dwordx4 v[32:35], v223, s[24:27], s44 offen sc1
    v_lshlrev_b32 v240, 16, v162
    v_and_b32 v241, 0xffff0000, v162
    v_pk_mul_f32 v[240:241], v[240:241], s[46:47]
    v_cvt_pk_bf16_f32 v162, v240, v241
    v_lshlrev_b32 v242, 16, v163
    v_and_b32 v243, 0xffff0000, v163
    v_pk_mul_f32 v[242:243], v[242:243], s[46:47]
    v_cvt_pk_bf16_f32 v163, v242, v243
    v_lshlrev_b32 v240, 16, v164
    v_and_b32 v241, 0xffff0000, v164
    v_pk_mul_f32 v[240:241], v[240:241], s[46:47]
    v_cvt_pk_bf16_f32 v164, v240, v241
    v_lshlrev_b32 v242, 16, v165
    v_and_b32 v243, 0xffff0000, v165
    v_pk_mul_f32 v[242:243], v[242:243], s[46:47]
    v_cvt_pk_bf16_f32 v165, v242, v243
    v_lshlrev_b32 v240, 16, v166
    v_and_b32 v241, 0xffff0000, v166
    v_pk_mul_f32 v[240:241], v[240:241], s[46:47]
    v_cvt_pk_bf16_f32 v166, v240, v241
    v_lshlrev_b32 v242, 16, v167
    v_and_b32 v243, 0xffff0000, v167
    v_pk_mul_f32 v[242:243], v[242:243], s[46:47]
    v_cvt_pk_bf16_f32 v167, v242, v243
    v_lshlrev_b32 v240, 16, v168
    s_add_u32 s44, s44, 4096
    s_min_u32 s54, s54, s28
    buffer_store_dwordx4 v[36:39], v223, s[24:27], s44 offen sc1
    v_and_b32 v241, 0xffff0000, v168
    v_pk_mul_f32 v[240:241], v[240:241], s[46:47]
    v_cvt_pk_bf16_f32 v168, v240, v241
    v_lshlrev_b32 v242, 16, v169
    v_and_b32 v243, 0xffff0000, v169
    v_pk_mul_f32 v[242:243], v[242:243], s[46:47]
    v_cvt_pk_bf16_f32 v169, v242, v243
    v_lshlrev_b32 v240, 16, v170
    v_and_b32 v241, 0xffff0000, v170
    v_pk_mul_f32 v[240:241], v[240:241], s[46:47]
    v_cvt_pk_bf16_f32 v170, v240, v241
    v_lshlrev_b32 v242, 16, v171
    v_and_b32 v243, 0xffff0000, v171
    v_pk_mul_f32 v[242:243], v[242:243], s[46:47]
    v_cvt_pk_bf16_f32 v171, v242, v243
    v_lshlrev_b32 v240, 16, v172
    v_and_b32 v241, 0xffff0000, v172
    v_pk_mul_f32 v[240:241], v[240:241], s[46:47]
    v_cvt_pk_bf16_f32 v172, v240, v241
    v_lshlrev_b32 v242, 16, v173
    v_and_b32 v243, 0xffff0000, v173
    v_pk_mul_f32 v[242:243], v[242:243], s[46:47]
    v_cvt_pk_bf16_f32 v173, v242, v243
    v_lshlrev_b32 v240, 16, v174
    v_and_b32 v241, 0xffff0000, v174
    s_add_u32 s44, s44, 4096
    s_add_u32 s54, s54, s55
    buffer_store_dwordx4 v[40:43], v223, s[24:27], s44 offen sc1
    v_pk_mul_f32 v[240:241], v[240:241], s[46:47]
    v_cvt_pk_bf16_f32 v174, v240, v241
    v_lshlrev_b32 v242, 16, v175
    v_and_b32 v243, 0xffff0000, v175
    v_pk_mul_f32 v[242:243], v[242:243], s[46:47]
    v_cvt_pk_bf16_f32 v175, v242, v243
    v_lshlrev_b32 v240, 16, v176
    v_and_b32 v241, 0xffff0000, v176
    v_pk_mul_f32 v[240:241], v[240:241], s[46:47]
    v_cvt_pk_bf16_f32 v176, v240, v241
    v_lshlrev_b32 v242, 16, v177
    v_and_b32 v243, 0xffff0000, v177
    v_pk_mul_f32 v[242:243], v[242:243], s[46:47]
    v_cvt_pk_bf16_f32 v177, v242, v243
    v_lshlrev_b32 v240, 16, v178
    v_and_b32 v241, 0xffff0000, v178
    v_pk_mul_f32 v[240:241], v[240:241], s[46:47]
    v_cvt_pk_bf16_f32 v178, v240, v241
    v_lshlrev_b32 v242, 16, v179
    v_and_b32 v243, 0xffff0000, v179
    v_pk_mul_f32 v[242:243], v[242:243], s[46:47]
    v_cvt_pk_bf16_f32 v179, v242, v243
    v_lshlrev_b32 v240, 16, v180
    v_and_b32 v241, 0xffff0000, v180
    v_pk_mul_f32 v[240:241], v[240:241], s[46:47]
    v_cvt_pk_bf16_f32 v180, v240, v241
    s_add_u32 s44, s44, 4096
    v_mfma_f32_32x32x16_bf16 v[0:15], a[108:111], a[108:111], 0
    s_lshl_b32 s54, s54, 16
    buffer_store_dwordx4 v[44:47], v223, s[24:27], s44 offen sc1
    v_lshlrev_b32 v240, 16, v181
    v_and_b32 v241, 0xffff0000, v181
    v_mul_f32 v240, s46, v240
    v_mul_f32 v241, s46, v241
    v_mfma_f32_32x32x16_bf16 v[16:31], a[108:111], a[108:111], 0
    s_add_u32 s83, s54, s74
    ds_read_b128 a[16:19], v228 offset:1024
    ds_read_b128 a[20:23], v229 offset:1024
    v_cvt_pk_bf16_f32 v181, v240, v241
    v_lshlrev_b32 v240, 16, v182
    v_and_b32 v241, 0xffff0000, v182
    v_mul_f32 v240, s46, v240
    v_mfma_f32_32x32x16_bf16 v[48:63], a[108:111], a[108:111], 0
    s_lshl_b32 s54, s91, 16
    ds_read_b128 a[24:27], v230 offset:1024
    ds_read_b128 a[28:31], v231 offset:1024
    v_mul_f32 v241, s46, v241
    v_cvt_pk_bf16_f32 v182, v240, v241
    v_lshlrev_b32 v240, 16, v183
    v_and_b32 v241, 0xffff0000, v183
    v_mfma_f32_32x32x16_bf16 v[64:79], a[108:111], a[108:111], 0
    s_add_u32 s54, s54, s83
    ds_read_b128 v[184:187], v217 offset:8448
    ds_read_b128 v[188:191], v218 offset:8448
    v_mul_f32 v240, s46, v240
    v_mul_f32 v241, s46, v241
    v_cvt_pk_bf16_f32 v183, v240, v241
    v_add_u32 v232, s39, v204
    v_mfma_f32_32x32x16_bf16 v[80:95], a[108:111], a[108:111], 0
    s_sub_u32 s54, s54, 3840
    ds_read_b128 v[192:195], v219 offset:8448
    ds_read_b128 v[196:199], v220 offset:8448
    v_add_u32 v233, s39, v205
    v_add_u32 v234, s39, v206
    v_add_u32 v235, s39, v207
    v_add_u32 v236, s39, v208
    v_mfma_f32_32x32x16_bf16 v[32:47], a[108:111], a[108:111], 0
    s_min_u32 s87, s54, s34
    v_add_u32 v237, s39, v209
    v_add_u32 v238, s39, v210
    v_add_u32 v239, s39, v211
    v_cvt_f32_u32 v244, s45
    v_sub_f32 v244, 0, v244
    v_accvgpr_write_b32 a88, v244
    v_accvgpr_write_b32 a92, v244
    v_accvgpr_write_b32 a96, v244
    s_mov_b32 s14, 0
    s_mov_b32 s36, s37
    s_mov_b32 s82, s75
    s_cmp_eq_u32 s84, 3
    s_cbranch_scc0 L_pro2
L_pro3:
    s_waitcnt lgkmcnt(0)
    v_lshlrev_b32 v240, 16, v184
    v_and_b32 v241, 0xffff0000, v184
    v_pk_mul_f32 v[240:241], v[240:241], s[46:47]
    v_cvt_pk_bf16_f32 v184, v240, v241
    v_lshlrev_b32 v242, 16, v185
    v_and_b32 v243, 0xffff0000, v185
    v_pk_mul_f32 v[242:243], v[242:243], s[46:47]
    v_cvt_pk_bf16_f32 v185, v242, v243
    v_lshlrev_b32 v240, 16, v186
    v_and_b32 v241, 0xffff0000, v186
    v_pk_mul_f32 v[240:241], v[240:241], s[46:47]
    v_cvt_pk_bf16_f32 v186, v240, v241
    v_lshlrev_b32 v242, 16, v187
    v_and_b32 v243, 0xffff0000, v187
    v_pk_mul_f32 v[242:243], v[242:243], s[46:47]
    v_cvt_pk_bf16_f32 v187, v242, v243
    v_lshlrev_b32 v240, 16, v188
    v_and_b32 v241, 0xffff0000, v188
    v_pk_mul_f32 v[240:241], v[240:241], s[46:47]
    v_cvt_pk_bf16_f32 v188, v240, v241
    v_lshlrev_b32 v242, 16, v189
    v_and_b32 v243, 0xffff0000, v189
    v_pk_mul_f32 v[242:243], v[242:243], s[46:47]
    v_cvt_pk_bf16_f32 v189, v242, v243
    v_lshlrev_b32 v240, 16, v190
    v_and_b32 v241, 0xffff0000, v190
    v_pk_mul_f32 v[240:241], v[240:241], s[46:47]
    v_cvt_pk_bf16_f32 v190, v240, v241
    v_lshlrev_b32 v242, 16, v191
    v_and_b32 v243, 0xffff0000, v191
    v_pk_mul_f32 v[242:243], v[242:243], s[46:47]
    v_cvt_pk_bf16_f32 v191, v242, v243
    v_lshlrev_b32 v240, 16, v192
    v_and_b32 v241, 0xffff0000, v192
    v_pk_mul_f32 v[240:241], v[240:241], s[46:47]
    v_cvt_pk_bf16_f32 v192, v240, v241
    v_lshlrev_b32 v242, 16, v193
    v_and_b32 v243, 0xffff0000, v193
    v_pk_mul_f32 v[242:243], v[242:243], s[46:47]
    v_cvt_pk_bf16_f32 v193, v242, v243
    v_lshlrev_b32 v240, 16, v194
    v_and_b32 v241, 0xffff0000, v194
    v_pk_mul_f32 v[240:241], v[240:241], s[46:47]
    v_cvt_pk_bf16_f32 v194, v240, v241
    v_lshlrev_b32 v242, 16, v195
    v_and_b32 v243, 0xffff0000, v195
    v_pk_mul_f32 v[242:243], v[242:243], s[46:47]
    v_cvt_pk_bf16_f32 v195, v242, v243
    v_lshlrev_b32 v240, 16, v196
    v_and_b32 v241, 0xffff0000, v196
    v_pk_mul_f32 v[240:241], v[240:241], s[46:47]
    v_cvt_pk_bf16_f32 v196, v240, v241
    v_lshlrev_b32 v242, 16, v197
    v_and_b32 v243, 0xffff0000, v197
    v_pk_mul_f32 v[242:243], v[242:243], s[46:47]
    v_cvt_pk_bf16_f32 v197, v242, v243
    v_lshlrev_b32 v240, 16, v198
    v_and_b32 v241, 0xffff0000, v198
    v_pk_mul_f32 v[240:241], v[240:241], s[46:47]
    v_cvt_pk_bf16_f32 v198, v240, v241
    v_lshlrev_b32 v242, 16, v199
    v_and_b32 v243, 0xffff0000, v199
    v_pk_mul_f32 v[242:243], v[242:243], s[46:47]
    v_cvt_pk_bf16_f32 v199, v242, v243
    s_barrier
    v_mfma_f32_16x16x32_bf16 v[128:131], a[0:3], v[152:155], 0
    s_mov_b32 s31, s32
    ds_read_b64_tr_b16 a[32:33], v232 offset:0
    ds_read_b64_tr_b16 a[34:35], v232 offset:1024
    v_mfma_f32_16x16x32_bf16 v[128:131], a[4:7], v[156:159], v[128:131]
    s_mov_b32 s22, s18
    ds_read_b64_tr_b16 a[36:37], v233 offset:0
    ds_read_b64_tr_b16 a[38:39], v233 offset:1024
    v_mfma_f32_16x16x32_bf16 v[128:131], a[8:11], v[160:163], v[128:131]
    s_sub_u32 s32, s32, 131072
    ds_read_b64_tr_b16 a[40:41], v234 offset:0
    ds_read_b64_tr_b16 a[42:43], v234 offset:1024
    v_mfma_f32_16x16x32_bf16 v[128:131], a[12:15], v[164:167], v[128:131]
    s_cmp_eq_u32 s32, s33
    ds_read_b64_tr_b16 a[44:45], v235 offset:0
    ds_read_b64_tr_b16 a[46:47], v235 offset:1024
    v_mfma_f32_16x16x32_bf16 v[132:135], a[16:19], v[152:155], 0
    s_cselect_b32 s18, s34, s18
    ds_read_b64_tr_b16 a[48:49], v236 offset:0
    ds_read_b64_tr_b16 a[50:51], v236 offset:1024
    v_mfma_f32_16x16x32_bf16 v[132:135], a[20:23], v[156:159], v[132:135]
    s_cselect_b64 s[32:33], s[80:81], s[32:33]
    ds_read_b64_tr_b16 a[52:53], v237 offset:0
    ds_read_b64_tr_b16 a[54:55], v237 offset:1024
    v_mfma_f32_16x16x32_bf16 v[132:135], a[24:27], v[160:163], v[132:135]
    s_cmp_lg_u64 s[48:49], 0
    ds_read_b64_tr_b16 a[56:57], v238 offset:0
    ds_read_b64_tr_b16 a[58:59], v238 offset:1024
    v_mfma_f32_16x16x32_bf16 v[132:135], a[28:31], v[164:167], v[132:135]
    s_cselect_b32 s57, s41, 0
    v_mfma_f32_16x16x32_bf16 v[136:139], a[0:3], v[168:171], 0
    s_or_b32 s40, s40, s57
    v_exp_f32 v128, v128
    v_mfma_f32_16x16x32_bf16 v[136:139], a[4:7], v[172:175], v[136:139]
    s_lshl_b32 s41, s41, 1
    v_exp_f32 v129, v129
    v_mfma_f32_16x16x32_bf16 v[136:139], a[8:11], v[176:179], v[136:139]
    s_mov_b64 vcc, 0
    v_exp_f32 v130, v130
    v_mfma_f32_16x16x32_bf16 v[136:139], a[12:15], v[180:183], v[136:139]
    s_mov_b64 s[72:73], 0
    v_exp_f32 v131, v131
    v_mfma_f32_16x16x32_bf16 v[140:143], a[16:19], v[168:171], 0
    s_mov_b64 s[74:75], 0
    v_exp_f32 v132, v132
    v_mfma_f32_16x16x32_bf16 v[140:143], a[20:23], v[172:175], v[140:143]
    s_lshr_b32 s63, s39, 13
    v_exp_f32 v133, v133
    v_mfma_f32_16x16x32_bf16 v[140:143], a[24:27], v[176:179], v[140:143]
    v_exp_f32 v134, v134
    v_mfma_f32_16x16x32_bf16 v[140:143], a[28:31], v[180:183], v[140:143]
    v_exp_f32 v135, v135
    v_cvt_pk_bf16_f32 v144, v128, v129
    v_cvt_pk_bf16_f32 v145, v130, v131
    v_cvt_pk_bf16_f32 v146, v132, v133
    v_cvt_pk_bf16_f32 v147, v134, v135
    s_cmp_eq_u32 s63, 0
    s_cbranch_scc1 L_body3_1
    s_cmp_eq_u32 s63, 1
    s_cbranch_scc1 L_body3_2
    s_cmp_eq_u32 s63, 2
    s_cbranch_scc1 L_body3_3
    s_cmp_eq_u32 s63, 3
    s_cbranch_scc1 L_body3_4
    s_branch L_body3_0
.p2align 12
L_ch3:
    v_cmp_eq_u32 s[54:55], 6, v247
    v_cmp_eq_u32 s[56:57], 7, v247
    s_nop 0
    v_cndmask_b32 v240, 0, v246, s[54:55]
    v_cndmask_b32 v241, 0, v246, s[56:57]
    v_accvgpr_write_b32 a70, v240
    v_accvgpr_write_b32 a71, v241
    s_mov_b32 s51, 1023410176
    s_mov_b32 s52, 578813952
    s_mov_b32 s40, 0
    s_mov_b32 s41, 1
    s_mov_b64 vcc, 0
    s_branch L_dfr
L_fin2:
    v_accvgpr_read_b32 v250, a88
    v_rcp_f32 v248, v250
    v_subrev_u32 v250, s51, v250
    v_cmp_le_u32 vcc, s52, v250
    v_pk_mul_f32 v[0:1], v[0:1], v[248:249] op_sel_hi:[1,0]
    v_pk_mul_f32 v[2:3], v[2:3], v[248:249] op_sel_hi:[1,0]
    v_pk_mul_f32 v[4:5], v[4:5], v[248:249] op_sel_hi:[1,0]
    v_pk_mul_f32 v[6:7], v[6:7], v[248:249] op_sel_hi:[1,0]
    v_pk_mul_f32 v[8:9], v[8:9], v[248:249] op_sel_hi:[1,0]
    v_pk_mul_f32 v[10:11], v[10:11], v[248:249] op_sel_hi:[1,0]
    v_pk_mul_f32 v[12:13], v[12:13], v[248:249] op_sel_hi:[1,0]
    v_pk_mul_f32 v[14:15], v[14:15], v[248:249] op_sel_hi:[1,0]
    v_pk_mul_f32 v[16:17], v[16:17], v[248:249] op_sel_hi:[1,0]
    v_pk_mul_f32 v[18:19], v[18:19], v[248:249] op_sel_hi:[1,0]
    v_pk_mul_f32 v[20:21], v[20:21], v[248:249] op_sel_hi:[1,0]
    v_pk_mul_f32 v[22:23], v[22:23], v[248:249] op_sel_hi:[1,0]
    v_pk_mul_f32 v[24:25], v[24:25], v[248:249] op_sel_hi:[1,0]
    v_pk_mul_f32 v[26:27], v[26:27], v[248:249] op_sel_hi:[1,0]
    v_pk_mul_f32 v[28:29], v[28:29], v[248:249] op_sel_hi:[1,0]
    v_pk_mul_f32 v[30:31], v[30:31], v[248:249] op_sel_hi:[1,0]
    v_cvt_pk_bf16_f32 v184, v0, v4
    v_cvt_pk_bf16_f32 v185, v8, v12
    v_cvt_pk_bf16_f32 v186, v16, v20
    v_cvt_pk_bf16_f32 v187, v24, v28
    v_cvt_pk_bf16_f32 v188, v1, v5
    v_cvt_pk_bf16_f32 v189, v9, v13
    v_cvt_pk_bf16_f32 v190, v17, v21
    v_cvt_pk_bf16_f32 v191, v25, v29
    v_mfma_f32_16x16x32_bf16 v[152:155], v[184:187], a[64:67], 0
    s_or_b64 s[48:49], s[48:49], vcc
    v_cvt_pk_bf16_f32 v192, v2, v6
    v_cvt_pk_bf16_f32 v193, v10, v14
    v_mfma_f32_16x16x32_bf16 v[168:171], v[184:187], a[68:71], 0
    v_cvt_pk_bf16_f32 v194, v18, v22
    v_cvt_pk_bf16_f32 v195, v26, v30
    v_mfma_f32_16x16x32_bf16 v[156:159], v[188:191], a[64:67], 0
    v_cvt_pk_bf16_f32 v196, v3, v7
    v_cvt_pk_bf16_f32 v197, v11, v15
    v_mfma_f32_16x16x32_bf16 v[172:175], v[188:191], a[68:71], 0
    v_cvt_pk_bf16_f32 v198, v19, v23
    v_cvt_pk_bf16_f32 v199, v27, v31
    v_mfma_f32_16x16x32_bf16 v[160:163], v[192:195], a[64:67], 0
    s_nop 0
    v_mfma_f32_16x16x32_bf16 v[176:179], v[192:195], a[68:71], 0
    s_nop 0
    v_mfma_f32_16x16x32_bf16 v[164:167], v[196:199], a[64:67], 0
    v_cvt_pk_bf16_f32 v0, v152, v156
    v_cvt_pk_bf16_f32 v4, v153, v157
    v_mfma_f32_16x16x32_bf16 v[180:183], v[196:199], a[68:71], 0
    v_cvt_pk_bf16_f32 v8, v154, v158
    v_cvt_pk_bf16_f32 v12, v155, v159
    v_mfma_f32_16x16x32_bf16 a[92:95], a[104:107], v[148:151], a[92:95]
    v_cvt_pk_bf16_f32 v2, v168, v172
    v_cvt_pk_bf16_f32 v6, v169, v173
    v_mfma_f32_16x16x32_bf16 v[32:35], a[32:35], v[148:151], v[32:35]
    v_cvt_pk_bf16_f32 v10, v170, v174
    v_cvt_pk_bf16_f32 v14, v171, v175
    v_mfma_f32_16x16x32_bf16 v[36:39], a[36:39], v[148:151], v[36:39]
    v_cvt_pk_bf16_f32 v1, v160, v164
    v_cvt_pk_bf16_f32 v5, v161, v165
    v_mfma_f32_16x16x32_bf16 v[40:43], a[40:43], v[148:151], v[40:43]
    v_cvt_pk_bf16_f32 v3, v176, v180
    v_cvt_pk_bf16_f32 v9, v162, v166
    v_mfma_f32_16x16x32_bf16 v[44:47], a[44:47], v[148:151], v[44:47]
    buffer_store_dwordx4 v[0:3], v223, s[24:27], s44 offen sc1
    v_cvt_pk_bf16_f32 v7, v177, v181
    v_mfma_f32_16x16x32_bf16 v[48:51], a[48:51], v[148:151], v[48:51]
    s_add_u32 s44, s44, 4096
    v_cvt_pk_bf16_f32 v13, v163, v167
    v_cvt_pk_bf16_f32 v11, v178, v182
    v_mfma_f32_16x16x32_bf16 v[52:55], a[52:55], v[148:151], v[52:55]
    v_cvt_pk_bf16_f32 v15, v179, v183
    v_accvgpr_read_b32 v250, a92
    v_mfma_f32_16x16x32_bf16 v[56:59], a[56:59], v[148:151], v[56:59]
    v_rcp_f32 v248, v250
    v_mfma_f32_16x16x32_bf16 v[60:63], a[60:63], v[148:151], v[60:63]
    v_subrev_u32 v250, s51, v250
    v_cmp_le_u32 vcc, s52, v250
    v_pk_mul_f32 v[32:33], v[32:33], v[248:249] op_sel_hi:[1,0]
    v_pk_mul_f32 v[34:35], v[34:35], v[248:249] op_sel_hi:[1,0]
    v_pk_mul_f32 v[36:37], v[36:37], v[248:249] op_sel_hi:[1,0]
    v_pk_mul_f32 v[38:39], v[38:39], v[248:249] op_sel_hi:[1,0]
    v_pk_mul_f32 v[40:41], v[40:41], v[248:249] op_sel_hi:[1,0]
    v_pk_mul_f32 v[42:43], v[42:43], v[248:249] op_sel_hi:[1,0]
    buffer_store_dwordx4 v[4:7], v223, s[24:27], s44 offen sc1
    v_pk_mul_f32 v[44:45], v[44:45], v[248:249] op_sel_hi:[1,0]
    v_pk_mul_f32 v[46:47], v[46:47], v[248:249] op_sel_hi:[1,0]
    v_pk_mul_f32 v[48:49], v[48:49], v[248:249] op_sel_hi:[1,0]
    v_pk_mul_f32 v[50:51], v[50:51], v[248:249] op_sel_hi:[1,0]
    v_pk_mul_f32 v[52:53], v[52:53], v[248:249] op_sel_hi:[1,0]
    v_pk_mul_f32 v[54:55], v[54:55], v[248:249] op_sel_hi:[1,0]
    v_pk_mul_f32 v[56:57], v[56:57], v[248:249] op_sel_hi:[1,0]
    v_pk_mul_f32 v[58:59], v[58:59], v[248:249] op_sel_hi:[1,0]
    v_pk_mul_f32 v[60:61], v[60:61], v[248:249] op_sel_hi:[1,0]
    v_pk_mul_f32 v[62:63], v[62:63], v[248:249] op_sel_hi:[1,0]
    v_cvt_pk_bf16_f32 v184, v32, v36
    v_cvt_pk_bf16_f32 v185, v40, v44
    v_cvt_pk_bf16_f32 v186, v48, v52
    s_add_u32 s44, s44, 4096
    buffer_store_dwordx4 v[8:11], v223, s[24:27], s44 offen sc1
    v_cvt_pk_bf16_f32 v187, v56, v60
    v_cvt_pk_bf16_f32 v188, v33, v37
    v_cvt_pk_bf16_f32 v189, v41, v45
    v_cvt_pk_bf16_f32 v190, v49, v53
    v_cvt_pk_bf16_f32 v191, v57, v61
    v_mfma_f32_16x16x32_bf16 v[152:155], v[184:187], a[64:67], 0
    s_or_b64 s[48:49], s[48:49], vcc
    v_cvt_pk_bf16_f32 v192, v34, v38
    v_cvt_pk_bf16_f32 v193, v42, v46
    v_mfma_f32_16x16x32_bf16 v[168:171], v[184:187], a[68:71], 0
    v_cvt_pk_bf16_f32 v194, v50, v54
    v_cvt_pk_bf16_f32 v195, v58, v62
    v_mfma_f32_16x16x32_bf16 v[156:159], v[188:191], a[64:67], 0
    v_cvt_pk_bf16_f32 v196, v35, v39
    s_add_u32 s44, s44, 4096
    buffer_store_dwordx4 v[12:15], v223, s[24:27], s44 offen sc1
    v_cvt_pk_bf16_f32 v197, v43, v47
    v_mfma_f32_16x16x32_bf16 v[172:175], v[188:191], a[68:71], 0
    v_cvt_pk_bf16_f32 v198, v51, v55
    v_cvt_pk_bf16_f32 v199, v59, v63
    v_mfma_f32_16x16x32_bf16 v[160:163], v[192:195], a[64:67], 0
    s_nop 0
    v_mfma_f32_16x16x32_bf16 v[176:179], v[192:195], a[68:71], 0
    s_nop 0
    v_mfma_f32_16x16x32_bf16 v[164:167], v[196:199], a[64:67], 0
    v_cvt_pk_bf16_f32 v32, v152, v156
    v_cvt_pk_bf16_f32 v36, v153, v157
    v_mfma_f32_16x16x32_bf16 v[180:183], v[196:199], a[68:71], 0
    v_cvt_pk_bf16_f32 v40, v154, v158
    v_cvt_pk_bf16_f32 v44, v155, v159
    s_add_u32 s44, s44, 53248
    v_cvt_pk_bf16_f32 v34, v168, v172
    v_cvt_pk_bf16_f32 v38, v169, v173
    v_cvt_pk_bf16_f32 v42, v170, v174
    v_cvt_pk_bf16_f32 v46, v171, v175
    v_cvt_pk_bf16_f32 v33, v160, v164
    v_cvt_pk_bf16_f32 v37, v161, v165
    v_cvt_pk_bf16_f32 v35, v176, v180
    v_cvt_pk_bf16_f32 v41, v162, v166
    buffer_store_dwordx4 v[32:35], v223, s[24:27], s44 offen sc1
    v_cvt_pk_bf16_f32 v39, v177, v181
    v_cvt_pk_bf16_f32 v45, v163, v167
    s_add_u32 s44, s44, 4096
    buffer_store_dwordx4 v[36:39], v223, s[24:27], s44 offen sc1
    v_cvt_pk_bf16_f32 v43, v178, v182
    s_add_u32 s44, s44, 4096
    buffer_store_dwordx4 v[40:43], v223, s[24:27], s44 offen sc1
    v_cvt_pk_bf16_f32 v47, v179, v183
    s_add_u32 s44, s44, 4096
    buffer_store_dwordx4 v[44:47], v223, s[24:27], s44 offen sc1
    s_cmp_lg_u64 s[48:49], 0
    s_cselect_b32 s57, s41, 0
    s_or_b32 s40, s40, s57
    s_cbranch_scc1 L_slow
    s_endpgm
.fill 68, 4, 0xbf810000
L_first3:
    s_waitcnt vmcnt(8)
    ds_read_b128 v[152:155], v217 offset:0
    ds_read_b128 v[156:159], v218 offset:0
    ds_read_b128 v[160:163], v219 offset:0
    ds_read_b128 v[164:167], v220 offset:0
    s_bfe_u32 s91, s71, 196637
    s_bfe_u32 s54, s71, 131099
    s_mul_i32 s55, s91, s28
    s_cmp_lt_u32 s28, s54
    s_addc_u32 s91, s91, 0
    s_waitcnt lgkmcnt(3)
    v_lshlrev_b32 v240, 16, v152
    s_min_u32 s54, s54, s28
    v_and_b32 v241, 0xffff0000, v152
    s_add_u32 s54, s54, s55
    v_pk_mul_f32 v[240:241], v[240:241], s[46:47]
    s_lshl_b32 s54, s54, 16
    v_cvt_pk_bf16_f32 v152, v240, v241
    s_add_u32 s83, s54, s70
    v_lshlrev_b32 v242, 16, v153
    s_lshl_b32 s54, s91, 16
    v_and_b32 v243, 0xffff0000, v153
    s_add_u32 s54, s54, s83
    v_pk_mul_f32 v[242:243], v[242:243], s[46:47]
    s_sub_u32 s54, s54, 3840
    v_cvt_pk_bf16_f32 v153, v242, v243
    s_min_u32 s87, s54, s34
    v_lshlrev_b32 v240, 16, v154
    v_and_b32 v241, 0xffff0000, v154
    v_pk_mul_f32 v[240:241], v[240:241], s[46:47]
    v_cvt_pk_bf16_f32 v154, v240, v241
    v_lshlrev_b32 v242, 16, v155
    v_and_b32 v243, 0xffff0000, v155
    v_pk_mul_f32 v[242:243], v[242:243], s[46:47]
    v_cvt_pk_bf16_f32 v155, v242, v243
    s_waitcnt lgkmcnt(2)
    v_lshlrev_b32 v240, 16, v156
    v_and_b32 v241, 0xffff0000, v156
    v_pk_mul_f32 v[240:241], v[240:241], s[46:47]
    v_cvt_pk_bf16_f32 v156, v240, v241
    v_lshlrev_b32 v242, 16, v157
    v_and_b32 v243, 0xffff0000, v157
    v_pk_mul_f32 v[242:243], v[242:243], s[46:47]
    v_cvt_pk_bf16_f32 v157, v242, v243
    v_lshlrev_b32 v240, 16, v158
    v_and_b32 v241, 0xffff0000, v158
    v_pk_mul_f32 v[240:241], v[240:241], s[46:47]
    v_cvt_pk_bf16_f32 v158, v240, v241
    s_barrier
    ds_read_b128 a[0:3], v200 offset:24576
    ds_read_b128 a[4:7], v201 offset:24576
    v_lshlrev_b32 v242, 16, v159
    v_and_b32 v243, 0xffff0000, v159
    v_pk_mul_f32 v[242:243], v[242:243], s[46:47]
    v_cvt_pk_bf16_f32 v159, v242, v243
    s_waitcnt lgkmcnt(3)
    v_lshlrev_b32 v240, 16, v160
    v_and_b32 v241, 0xffff0000, v160
    v_pk_mul_f32 v[240:241], v[240:241], s[46:47]
    v_cvt_pk_bf16_f32 v160, v240, v241
    ds_read_b128 a[8:11], v202 offset:24576
    ds_read_b128 a[12:15], v203 offset:24576
    v_lshlrev_b32 v242, 16, v161
    v_and_b32 v243, 0xffff0000, v161
    v_pk_mul_f32 v[242:243], v[242:243], s[46:47]
    v_cvt_pk_bf16_f32 v161, v242, v243
    v_lshlrev_b32 v240, 16, v162
    v_and_b32 v241, 0xffff0000, v162
    v_pk_mul_f32 v[240:241], v[240:241], s[46:47]
    v_cvt_pk_bf16_f32 v162, v240, v241
    ds_read_b128 a[16:19], v200 offset:25600
    ds_read_b128 a[20:23], v201 offset:25600
    v_lshlrev_b32 v242, 16, v163
    v_and_b32 v243, 0xffff0000, v163
    v_pk_mul_f32 v[242:243], v[242:243], s[46:47]
    v_cvt_pk_bf16_f32 v163, v242, v243
    s_waitcnt lgkmcnt(6)
    v_lshlrev_b32 v240, 16, v164
    v_and_b32 v241, 0xffff0000, v164
    v_pk_mul_f32 v[240:241], v[240:241], s[46:47]
    v_cvt_pk_bf16_f32 v164, v240, v241
    ds_read_b128 a[24:27], v202 offset:25600
    ds_read_b128 a[28:31], v203 offset:25600
    v_lshlrev_b32 v242, 16, v165
    v_and_b32 v243, 0xffff0000, v165
    v_pk_mul_f32 v[242:243], v[242:243], s[46:47]
    v_cvt_pk_bf16_f32 v165, v242, v243
    v_lshlrev_b32 v240, 16, v166
    v_and_b32 v241, 0xffff0000, v166
    v_pk_mul_f32 v[240:241], v[240:241], s[46:47]
    v_cvt_pk_bf16_f32 v166, v240, v241
    v_lshlrev_b32 v242, 16, v167
    v_and_b32 v243, 0xffff0000, v167
    v_pk_mul_f32 v[242:243], v[242:243], s[46:47]
    v_cvt_pk_bf16_f32 v167, v242, v243
    s_waitcnt vmcnt(4) lgkmcnt(0)
    s_add_u32 m0, s29, 73728
    v_mfma_f32_16x16x32_bf16 v[128:131], a[0:3], v[152:155], 0
    s_mov_b32 s14, 0
    ds_read_b128 v[168:171], v217 offset:4224
    v_mfma_f32_16x16x32_bf16 v[128:131], a[4:7], v[156:159], v[128:131]
    s_mov_b32 s36, s37
    buffer_load_dwordx4 v212, s[20:23], s31 offen offset:0  lds
    v_mfma_f32_16x16x32_bf16 v[128:131], a[8:11], v[160:163], v[128:131]
    s_mov_b32 s82, s71
    ds_read_b128 v[172:175], v218 offset:4224
    v_mfma_f32_16x16x32_bf16 v[128:131], a[12:15], v[164:167], v[128:131]
    buffer_load_dwordx4 v213, s[20:23], s31 offen offset:1024  lds
    v_mfma_f32_16x16x32_bf16 v[132:135], a[16:19], v[152:155], 0
    s_add_u32 m0, s29, 32768
    ds_read_b128 v[176:179], v219 offset:4224
    v_mfma_f32_16x16x32_bf16 v[132:135], a[20:23], v[156:159], v[132:135]
    buffer_load_dwordx4 v214, s[16:19], s32 offen offset:0  lds
    v_mfma_f32_16x16x32_bf16 v[132:135], a[24:27], v[160:163], v[132:135]
    ds_read_b128 v[180:183], v220 offset:4224
    v_mfma_f32_16x16x32_bf16 v[132:135], a[28:31], v[164:167], v[132:135]
    buffer_load_dwordx4 v215, s[16:19], s32 offen offset:1024  lds
    s_mov_b32 s31, s32
    v_exp_f32 v128, v128
    s_mov_b32 s22, s18
    v_exp_f32 v129, v129
    s_sub_u32 s32, s32, 131072
    v_exp_f32 v130, v130
    v_exp_f32 v131, v131
    v_exp_f32 v132, v132
    v_exp_f32 v133, v133
    v_exp_f32 v134, v134
    v_exp_f32 v135, v135
    v_cvt_pk_bf16_f32 v144, v128, v129
    v_cvt_pk_bf16_f32 v145, v130, v131
    v_cvt_pk_bf16_f32 v146, v132, v133
    v_cvt_pk_bf16_f32 v147, v134, v135
    s_waitcnt lgkmcnt(3)
    v_lshlrev_b32 v240, 16, v168
    v_and_b32 v241, 0xffff0000, v168
    v_pk_mul_f32 v[240:241], v[240:241], s[46:47]
    v_cvt_pk_bf16_f32 v168, v240, v241
    v_lshlrev_b32 v242, 16, v169
    v_and_b32 v243, 0xffff0000, v169
    v_pk_mul_f32 v[242:243], v[242:243], s[46:47]
    v_cvt_pk_bf16_f32 v169, v242, v243
    v_lshlrev_b32 v240, 16, v170
    v_and_b32 v241, 0xffff0000, v170
    v_pk_mul_f32 v[240:241], v[240:241], s[46:47]
    v_cvt_pk_bf16_f32 v170, v240, v241
    s_add_u32 m0, s29, 40960
    s_nop 0
    buffer_load_dwordx4 v212, s[20:23], s31 offen offset:0  lds
    v_lshlrev_b32 v242, 16, v171
    v_and_b32 v243, 0xffff0000, v171
    v_pk_mul_f32 v[242:243], v[242:243], s[46:47]
    v_cvt_pk_bf16_f32 v171, v242, v243
    s_waitcnt lgkmcnt(2)
    v_lshlrev_b32 v240, 16, v172
    v_and_b32 v241, 0xffff0000, v172
    v_pk_mul_f32 v[240:241], v[240:241], s[46:47]
    v_cvt_pk_bf16_f32 v172, v240, v241
    v_lshlrev_b32 v242, 16, v173
    v_and_b32 v243, 0xffff0000, v173
    v_pk_mul_f32 v[242:243], v[242:243], s[46:47]
    v_cvt_pk_bf16_f32 v173, v242, v243
    buffer_load_dwordx4 v213, s[20:23], s31 offen offset:1024  lds
    v_lshlrev_b32 v240, 16, v174
    v_and_b32 v241, 0xffff0000, v174
    v_pk_mul_f32 v[240:241], v[240:241], s[46:47]
    v_cvt_pk_bf16_f32 v174, v240, v241
    v_lshlrev_b32 v242, 16, v175
    v_and_b32 v243, 0xffff0000, v175
    v_pk_mul_f32 v[242:243], v[242:243], s[46:47]
    v_cvt_pk_bf16_f32 v175, v242, v243
    s_waitcnt lgkmcnt(1)
    v_lshlrev_b32 v240, 16, v176
    v_and_b32 v241, 0xffff0000, v176
    v_pk_mul_f32 v[240:241], v[240:241], s[46:47]
    v_cvt_pk_bf16_f32 v176, v240, v241
    s_add_u32 m0, s29, 0
    s_nop 0
    buffer_load_dwordx4 v214, s[16:19], s32 offen offset:0  lds
    v_lshlrev_b32 v242, 16, v177
    v_and_b32 v243, 0xffff0000, v177
    v_pk_mul_f32 v[242:243], v[242:243], s[46:47]
    v_cvt_pk_bf16_f32 v177, v242, v243
    v_lshlrev_b32 v240, 16, v178
    v_and_b32 v241, 0xffff0000, v178
    v_pk_mul_f32 v[240:241], v[240:241], s[46:47]
    v_cvt_pk_bf16_f32 v178, v240, v241
    v_lshlrev_b32 v242, 16, v179
    v_and_b32 v243, 0xffff0000, v179
    v_pk_mul_f32 v[242:243], v[242:243], s[46:47]
    v_cvt_pk_bf16_f32 v179, v242, v243
    buffer_load_dwordx4 v215, s[16:19], s32 offen offset:1024  lds
    s_waitcnt lgkmcnt(0)
    v_lshlrev_b32 v240, 16, v180
    v_and_b32 v241, 0xffff0000, v180
    v_pk_mul_f32 v[240:241], v[240:241], s[46:47]
    v_cvt_pk_bf16_f32 v180, v240, v241
    v_lshlrev_b32 v242, 16, v181
    v_and_b32 v243, 0xffff0000, v181
    v_pk_mul_f32 v[242:243], v[242:243], s[46:47]
    v_cvt_pk_bf16_f32 v181, v242, v243
    v_lshlrev_b32 v240, 16, v182
    v_and_b32 v241, 0xffff0000, v182
    v_pk_mul_f32 v[240:241], v[240:241], s[46:47]
    v_cvt_pk_bf16_f32 v182, v240, v241
    v_lshlrev_b32 v242, 16, v183
    v_and_b32 v243, 0xffff0000, v183
    v_pk_mul_f32 v[242:243], v[242:243], s[46:47]
    v_cvt_pk_bf16_f32 v183, v242, v243
    s_mov_b32 s31, s32
    s_waitcnt vmcnt(8)
    v_mfma_f32_16x16x32_bf16 v[136:139], a[0:3], v[168:171], 0
    s_mov_b32 s22, s18
    ds_read_b128 v[184:187], v217 offset:8448
    v_mfma_f32_16x16x32_bf16 v[136:139], a[4:7], v[172:175], v[136:139]
    s_sub_u32 s32, s32, 131072
    ds_read_b128 v[188:191], v218 offset:8448
    v_mfma_f32_16x16x32_bf16 v[136:139], a[8:11], v[176:179], v[136:139]
    s_cmp_eq_u32 s32, s33
    ds_read_b128 v[192:195], v219 offset:8448
    v_mfma_f32_16x16x32_bf16 v[136:139], a[12:15], v[180:183], v[136:139]
    s_cselect_b32 s18, s34, s18
    ds_read_b128 v[196:199], v220 offset:8448
    v_mfma_f32_16x16x32_bf16 v[140:143], a[16:19], v[168:171], 0
    s_cselect_b64 s[32:33], s[80:81], s[32:33]
    v_mfma_f32_16x16x32_bf16 v[140:143], a[20:23], v[172:175], v[140:143]
    v_mfma_f32_16x16x32_bf16 v[140:143], a[24:27], v[176:179], v[140:143]
    v_mfma_f32_16x16x32_bf16 v[140:143], a[28:31], v[180:183], v[140:143]
    s_waitcnt lgkmcnt(3)
    v_lshlrev_b32 v240, 16, v184
    v_and_b32 v241, 0xffff0000, v184
    v_pk_mul_f32 v[240:241], v[240:241], s[46:47]
    v_cvt_pk_bf16_f32 v184, v240, v241
    v_lshlrev_b32 v242, 16, v185
    v_and_b32 v243, 0xffff0000, v185
    v_pk_mul_f32 v[242:243], v[242:243], s[46:47]
    v_cvt_pk_bf16_f32 v185, v242, v243
    v_lshlrev_b32 v240, 16, v186
    v_and_b32 v241, 0xffff0000, v186
    v_pk_mul_f32 v[240:241], v[240:241], s[46:47]
    v_cvt_pk_bf16_f32 v186, v240, v241
    s_add_u32 m0, s29, 49152
    s_nop 0
    buffer_load_dwordx4 v212, s[20:23], s31 offen offset:0  lds
    v_lshlrev_b32 v242, 16, v187
    v_and_b32 v243, 0xffff0000, v187
    v_pk_mul_f32 v[242:243], v[242:243], s[46:47]
    v_cvt_pk_bf16_f32 v187, v242, v243
    s_waitcnt lgkmcnt(2)
    v_lshlrev_b32 v240, 16, v188
    v_and_b32 v241, 0xffff0000, v188
    v_pk_mul_f32 v[240:241], v[240:241], s[46:47]
    v_cvt_pk_bf16_f32 v188, v240, v241
    v_lshlrev_b32 v242, 16, v189
    v_and_b32 v243, 0xffff0000, v189
    v_pk_mul_f32 v[242:243], v[242:243], s[46:47]
    v_cvt_pk_bf16_f32 v189, v242, v243
    buffer_load_dwordx4 v213, s[20:23], s31 offen offset:1024  lds
    v_lshlrev_b32 v240, 16, v190
    v_and_b32 v241, 0xffff0000, v190
    v_pk_mul_f32 v[240:241], v[240:241], s[46:47]
    v_cvt_pk_bf16_f32 v190, v240, v241
    v_lshlrev_b32 v242, 16, v191
    v_and_b32 v243, 0xffff0000, v191
    v_pk_mul_f32 v[242:243], v[242:243], s[46:47]
    v_cvt_pk_bf16_f32 v191, v242, v243
    s_waitcnt lgkmcnt(1)
    v_lshlrev_b32 v240, 16, v192
    v_and_b32 v241, 0xffff0000, v192
    v_pk_mul_f32 v[240:241], v[240:241], s[46:47]
    v_cvt_pk_bf16_f32 v192, v240, v241
    s_add_u32 m0, s29, 8192
    s_nop 0
    buffer_load_dwordx4 v214, s[16:19], s32 offen offset:0  lds
    v_lshlrev_b32 v242, 16, v193
    v_and_b32 v243, 0xffff0000, v193
    v_pk_mul_f32 v[242:243], v[242:243], s[46:47]
    v_cvt_pk_bf16_f32 v193, v242, v243
    v_lshlrev_b32 v240, 16, v194
    v_and_b32 v241, 0xffff0000, v194
    v_pk_mul_f32 v[240:241], v[240:241], s[46:47]
    v_cvt_pk_bf16_f32 v194, v240, v241
    v_lshlrev_b32 v242, 16, v195
    v_and_b32 v243, 0xffff0000, v195
    v_pk_mul_f32 v[242:243], v[242:243], s[46:47]
    v_cvt_pk_bf16_f32 v195, v242, v243
    buffer_load_dwordx4 v215, s[16:19], s32 offen offset:1024  lds
    s_waitcnt lgkmcnt(0)
    v_lshlrev_b32 v240, 16, v196
    v_and_b32 v241, 0xffff0000, v196
    v_pk_mul_f32 v[240:241], v[240:241], s[46:47]
    v_cvt_pk_bf16_f32 v196, v240, v241
    v_lshlrev_b32 v242, 16, v197
    v_and_b32 v243, 0xffff0000, v197
    v_pk_mul_f32 v[242:243], v[242:243], s[46:47]
    v_cvt_pk_bf16_f32 v197, v242, v243
    v_lshlrev_b32 v240, 16, v198
    v_and_b32 v241, 0xffff0000, v198
    v_pk_mul_f32 v[240:241], v[240:241], s[46:47]
    v_cvt_pk_bf16_f32 v198, v240, v241
    v_lshlrev_b32 v242, 16, v199
    v_and_b32 v243, 0xffff0000, v199
    v_pk_mul_f32 v[242:243], v[242:243], s[46:47]
    v_cvt_pk_bf16_f32 v199, v242, v243
    s_mov_b32 s31, s32
    s_mov_b32 s22, s18
    s_sub_u32 s32, s32, 131072
    s_cmp_eq_u32 s32, s33
    s_cselect_b32 s18, s34, s18
    s_cselect_b64 s[32:33], s[80:81], s[32:33]
    s_cmp_lt_i32 s89, 0
    s_cselect_b32 s35, s83, s35
    s_cselect_b32 s36, s30, s36
    s_cselect_b32 s14, s87, s14
    s_cmp_ge_i32 s86, s88
    s_cbranch_scc0 L_xarf3
    s_mov_b32 s56, s85
L_xalf3:
    s_mov_b32 m0, s36
    s_sub_u32 s56, s56, 1
    buffer_load_dwordx4 v216, s[12:15], s35 offen offset:0 nt lds
    s_add_u32 s35, s35, 16384
    s_add_u32 s36, s36, 1056
    s_min_u32 s36, s36, s37
    s_cmp_lg_u32 s56, 0
    s_cbranch_scc1 L_xalf3
L_xarf3:
    s_sub_u32 s38, s88, 1
    s_min_i32 s88, s38, s86
    s_max_i32 s88, s88, 0
    s_cmp_lg_u64 vcc, 0
    s_cselect_b32 s88, s38, s88
    s_sub_u32 s38, s38, s88
    s_waitcnt vmcnt(8)
    s_barrier
    ds_read_b64_tr_b16 a[32:33], v204 offset:32768
    s_mov_b32 m0, s36
    ds_read_b64_tr_b16 a[34:35], v204 offset:33792
    s_add_u32 s36, s36, 1056
    ds_read_b64_tr_b16 a[36:37], v205 offset:32768
    buffer_load_dwordx4 v216, s[12:15], s35 offen offset:0 nt lds
    ds_read_b64_tr_b16 a[38:39], v205 offset:33792
    s_add_u32 s35, s35, 16384
    ds_read_b64_tr_b16 a[40:41], v206 offset:32768
    s_min_u32 s36, s36, s37
    ds_read_b64_tr_b16 a[42:43], v206 offset:33792
    s_mov_b32 m0, s36
    ds_read_b64_tr_b16 a[44:45], v207 offset:32768
    s_add_u32 s36, s36, 1056
    ds_read_b64_tr_b16 a[46:47], v207 offset:33792
    buffer_load_dwordx4 v216, s[12:15], s35 offen offset:0 nt lds
    ds_read_b64_tr_b16 a[48:49], v208 offset:32768
    s_add_u32 s35, s35, 16384
    ds_read_b64_tr_b16 a[50:51], v208 offset:33792
    s_min_u32 s36, s36, s37
    ds_read_b64_tr_b16 a[52:53], v209 offset:32768
    s_add_u32 m0, s29, 57344
    ds_read_b64_tr_b16 a[54:55], v209 offset:33792
    s_nop 0
    ds_read_b64_tr_b16 a[56:57], v210 offset:32768
    buffer_load_dwordx4 v212, s[20:23], s31 offen offset:0  lds
    ds_read_b64_tr_b16 a[58:59], v210 offset:33792
    buffer_load_dwordx4 v213, s[20:23], s31 offen offset:1024  lds
    ds_read_b64_tr_b16 a[60:61], v211 offset:32768
    s_add_u32 m0, s29, 16384
    ds_read_b64_tr_b16 a[62:63], v211 offset:33792
    s_mov_b32 s22, s18
    buffer_load_dwordx4 v214, s[16:19], s32 offen offset:0  lds
    buffer_load_dwordx4 v215, s[16:19], s32 offen offset:1024  lds
    s_mov_b32 s31, s32
    s_sub_u32 s32, s32, 131072
    s_cmp_eq_u32 s32, s33
    s_cselect_b32 s18, s34, s18
    s_cselect_b64 s[32:33], s[80:81], s[32:33]
L_body3_0:
    v_mfma_f32_16x16x32_bf16 a[88:91], a[104:107], v[144:147], a[88:91]
    s_waitcnt lgkmcnt(1)
    ds_read_b64_tr_b16 a[60:61], v211 offset:32768
    v_mfma_f32_16x16x32_bf16 v[0:3], a[32:35], v[144:147], v[0:3]
    s_mov_b32 s39, 8192
    ds_read_b64_tr_b16 a[62:63], v211 offset:33792
    v_mfma_f32_16x16x32_bf16 v[4:7], a[36:39], v[144:147], v[4:7]
    s_mov_b32 s42, 0
    v_exp_f32 v136, v136
    v_mfma_f32_16x16x32_bf16 v[8:11], a[40:43], v[144:147], v[8:11]
    s_mov_b32 s43, 32768
    v_exp_f32 v137, v137
    v_mfma_f32_16x16x32_bf16 v[12:15], a[44:47], v[144:147], v[12:15]
    v_exp_f32 v138, v138
    v_mfma_f32_16x16x32_bf16 v[16:19], a[48:51], v[144:147], v[16:19]
    s_mov_b32 m0, s36
    v_exp_f32 v139, v139
    v_mfma_f32_16x16x32_bf16 v[20:23], a[52:55], v[144:147], v[20:23]
    s_waitcnt lgkmcnt(0)
    v_cvt_pk_bf16_f32 v148, v136, v137
    v_mfma_f32_16x16x32_bf16 v[24:27], a[56:59], v[144:147], v[24:27]
    buffer_load_dwordx4 v216, s[12:15], s35 offen offset:0 nt lds
    v_mfma_f32_16x16x32_bf16 v[28:31], a[60:63], v[144:147], v[28:31]
    v_exp_f32 v140, v140
    v_mfma_f32_16x16x32_bf16 v[96:99], a[0:3], v[184:187], 0
    v_exp_f32 v141, v141
    v_mfma_f32_16x16x32_bf16 v[96:99], a[4:7], v[188:191], v[96:99]
    v_exp_f32 v142, v142
    v_mfma_f32_16x16x32_bf16 v[96:99], a[8:11], v[192:195], v[96:99]
    ds_read_b128 a[0:3], v200 offset:32768
    v_cvt_pk_bf16_f32 v149, v138, v139
    v_mfma_f32_16x16x32_bf16 v[96:99], a[12:15], v[196:199], v[96:99]
    s_add_u32 m0, s29, 65536
    v_exp_f32 v143, v143
    v_mfma_f32_16x16x32_bf16 v[100:103], a[16:19], v[184:187], 0
    buffer_load_dwordx4 v212, s[20:23], s31 offen offset:0  lds
    v_mfma_f32_16x16x32_bf16 v[100:103], a[20:23], v[188:191], v[100:103]
    v_cvt_pk_bf16_f32 v150, v140, v141
    v_cvt_pk_bf16_f32 v151, v142, v143
    v_mfma_f32_16x16x32_bf16 v[100:103], a[24:27], v[192:195], v[100:103]
    ds_read_b128 a[4:7], v201 offset:32768
    v_mfma_f32_16x16x32_bf16 v[100:103], a[28:31], v[196:199], v[100:103]
    v_mfma_f32_16x16x32_bf16 v[32:35], a[32:35], v[148:151], v[32:35]
    buffer_load_dwordx4 v213, s[20:23], s31 offen offset:1024  lds
    v_mfma_f32_16x16x32_bf16 v[36:39], a[36:39], v[148:151], v[36:39]
    v_exp_f32 v96, v96
    v_mfma_f32_16x16x32_bf16 v[40:43], a[40:43], v[148:151], v[40:43]
    ds_read_b128 a[8:11], v202 offset:32768
    ds_read_b128 a[12:15], v203 offset:32768
    v_mfma_f32_16x16x32_bf16 v[44:47], a[44:47], v[148:151], v[44:47]
    v_exp_f32 v97, v97
    v_mfma_f32_16x16x32_bf16 v[48:51], a[48:51], v[148:151], v[48:51]
    ds_read_b128 a[16:19], v200 offset:33792
    v_cvt_pk_bf16_f32 v104, v96, v97
    v_mfma_f32_16x16x32_bf16 v[52:55], a[52:55], v[148:151], v[52:55]
    v_exp_f32 v98, v98
    v_mfma_f32_16x16x32_bf16 v[56:59], a[56:59], v[148:151], v[56:59]
    ds_read_b128 a[20:23], v201 offset:33792
    ds_read_b128 a[24:27], v202 offset:33792
    v_mfma_f32_16x16x32_bf16 v[60:63], a[60:63], v[148:151], v[60:63]
    v_exp_f32 v99, v99
    v_mfma_f32_16x16x32_bf16 a[92:95], a[104:107], v[148:151], a[92:95]
    s_waitcnt lgkmcnt(3)
    ds_read_b128 a[28:31], v203 offset:33792
    v_cvt_pk_bf16_f32 v105, v98, v99
    v_mfma_f32_16x16x32_bf16 v[128:131], a[0:3], v[152:155], 0
    s_add_u32 m0, s29, 24576
    v_exp_f32 v100, v100
    v_mfma_f32_16x16x32_bf16 v[128:131], a[4:7], v[156:159], v[128:131]
    buffer_load_dwordx4 v214, s[16:19], s32 offen offset:0  lds
    v_mfma_f32_16x16x32_bf16 v[128:131], a[8:11], v[160:163], v[128:131]
    v_exp_f32 v101, v101
    v_mfma_f32_16x16x32_bf16 v[128:131], a[12:15], v[164:167], v[128:131]
    s_waitcnt lgkmcnt(1)
    v_exp_f32 v102, v102
    v_mfma_f32_16x16x32_bf16 v[132:135], a[16:19], v[152:155], 0
    v_exp_f32 v103, v103
    v_mfma_f32_16x16x32_bf16 v[132:135], a[20:23], v[156:159], v[132:135]
    v_cvt_pk_bf16_f32 v106, v100, v101
    v_cvt_pk_bf16_f32 v107, v102, v103
    v_mfma_f32_16x16x32_bf16 v[132:135], a[24:27], v[160:163], v[132:135]
    s_waitcnt lgkmcnt(0)
    v_exp_f32 v128, v128
    v_mfma_f32_16x16x32_bf16 v[132:135], a[28:31], v[164:167], v[132:135]
    s_waitcnt vmcnt(14)
    buffer_load_dwordx4 v215, s[16:19], s32 offen offset:1024  lds
    v_mfma_f32_16x16x32_bf16 v[64:67], a[32:35], v[104:107], v[64:67]
    s_barrier
    ds_read_b64_tr_b16 a[32:33], v204 offset:0
    v_mfma_f32_16x16x32_bf16 v[68:71], a[36:39], v[104:107], v[68:71]
    s_add_u32 s35, s35, 16384
    v_exp_f32 v129, v129
    v_mfma_f32_16x16x32_bf16 v[72:75], a[40:43], v[104:107], v[72:75]
    s_add_u32 s36, s36, 1056
    v_exp_f32 v130, v130
    v_mfma_f32_16x16x32_bf16 v[76:79], a[44:47], v[104:107], v[76:79]
    s_min_u32 s36, s36, s37
    ds_read_b64_tr_b16 a[34:35], v204 offset:1024
    v_cvt_pk_bf16_f32 v144, v128, v129
    v_mfma_f32_16x16x32_bf16 v[80:83], a[48:51], v[104:107], v[80:83]
    s_sub_u32 s89, s89, 1
    ds_read_b64_tr_b16 a[36:37], v205 offset:0
    ds_read_b64_tr_b16 a[38:39], v205 offset:1024
    v_mfma_f32_16x16x32_bf16 v[84:87], a[52:55], v[104:107], v[84:87]
    s_cselect_b32 s35, s83, s35
    ds_read_b64_tr_b16 a[40:41], v206 offset:0
    ds_read_b64_tr_b16 a[42:43], v206 offset:1024
    v_mfma_f32_16x16x32_bf16 v[88:91], a[56:59], v[104:107], v[88:91]
    s_cselect_b32 s36, s30, s36
    v_exp_f32 v131, v131
    v_mfma_f32_16x16x32_bf16 v[92:95], a[60:63], v[104:107], v[92:95]
    s_cselect_b32 s14, s87, s14
    ds_read_b64_tr_b16 a[44:45], v207 offset:0
    ds_read_b64_tr_b16 a[46:47], v207 offset:1024
    v_mfma_f32_16x16x32_bf16 a[96:99], a[104:107], v[104:107], a[96:99]
    s_mov_b32 s31, s32
    ds_read_b64_tr_b16 a[48:49], v208 offset:0
    v_cvt_pk_bf16_f32 v145, v130, v131
    v_mfma_f32_16x16x32_bf16 v[136:139], a[0:3], v[168:171], 0
    s_mov_b32 s22, s18
    v_exp_f32 v132, v132
    v_mfma_f32_16x16x32_bf16 v[136:139], a[4:7], v[172:175], v[136:139]
    s_sub_u32 s32, s32, 131072
    ds_read_b64_tr_b16 a[50:51], v208 offset:1024
    v_exp_f32 v133, v133
    v_mfma_f32_16x16x32_bf16 v[136:139], a[8:11], v[176:179], v[136:139]
    s_cmp_eq_u32 s32, s33
    ds_read_b64_tr_b16 a[52:53], v209 offset:0
    v_cvt_pk_bf16_f32 v146, v132, v133
    v_mfma_f32_16x16x32_bf16 v[136:139], a[12:15], v[180:183], v[136:139]
    s_cselect_b32 s18, s34, s18
    ds_read_b64_tr_b16 a[54:55], v209 offset:1024
    ds_read_b64_tr_b16 a[56:57], v210 offset:0
    v_mfma_f32_16x16x32_bf16 v[140:143], a[16:19], v[168:171], 0
    s_cselect_b64 s[32:33], s[80:81], s[32:33]
    v_exp_f32 v134, v134
    v_mfma_f32_16x16x32_bf16 v[140:143], a[20:23], v[172:175], v[140:143]
    s_sub_u32 s38, s38, 1
    v_exp_f32 v135, v135
    v_mfma_f32_16x16x32_bf16 v[140:143], a[24:27], v[176:179], v[140:143]
    ds_read_b64_tr_b16 a[58:59], v210 offset:1024
    v_cvt_pk_bf16_f32 v147, v134, v135
    v_mfma_f32_16x16x32_bf16 v[140:143], a[28:31], v[180:183], v[140:143]
    s_cbranch_scc1 L_ex3
L_body3_1:
    v_mfma_f32_16x16x32_bf16 a[88:91], a[104:107], v[144:147], a[88:91]
    s_waitcnt lgkmcnt(1)
    ds_read_b64_tr_b16 a[60:61], v211 offset:0
    v_mfma_f32_16x16x32_bf16 v[0:3], a[32:35], v[144:147], v[0:3]
    s_mov_b32 s39, 16384
    ds_read_b64_tr_b16 a[62:63], v211 offset:1024
    v_mfma_f32_16x16x32_bf16 v[4:7], a[36:39], v[144:147], v[4:7]
    s_mov_b32 s42, 8192
    v_exp_f32 v136, v136
    v_mfma_f32_16x16x32_bf16 v[8:11], a[40:43], v[144:147], v[8:11]
    s_mov_b32 s43, 0
    v_exp_f32 v137, v137
    v_mfma_f32_16x16x32_bf16 v[12:15], a[44:47], v[144:147], v[12:15]
    v_exp_f32 v138, v138
    v_mfma_f32_16x16x32_bf16 v[16:19], a[48:51], v[144:147], v[16:19]
    s_mov_b32 m0, s36
    v_exp_f32 v139, v139
    v_mfma_f32_16x16x32_bf16 v[20:23], a[52:55], v[144:147], v[20:23]
    s_waitcnt lgkmcnt(0)
    v_cvt_pk_bf16_f32 v148, v136, v137
    v_mfma_f32_16x16x32_bf16 v[24:27], a[56:59], v[144:147], v[24:27]
    buffer_load_dwordx4 v216, s[12:15], s35 offen offset:0 nt lds
    v_mfma_f32_16x16x32_bf16 v[28:31], a[60:63], v[144:147], v[28:31]
    v_exp_f32 v140, v140
    v_mfma_f32_16x16x32_bf16 v[96:99], a[0:3], v[184:187], 0
    v_exp_f32 v141, v141
    v_mfma_f32_16x16x32_bf16 v[96:99], a[4:7], v[188:191], v[96:99]
    v_exp_f32 v142, v142
    v_mfma_f32_16x16x32_bf16 v[96:99], a[8:11], v[192:195], v[96:99]
    ds_read_b128 a[0:3], v200 offset:0
    v_cvt_pk_bf16_f32 v149, v138, v139
    v_mfma_f32_16x16x32_bf16 v[96:99], a[12:15], v[196:199], v[96:99]
    s_add_u32 m0, s29, 73728
    v_exp_f32 v143, v143
    v_mfma_f32_16x16x32_bf16 v[100:103], a[16:19], v[184:187], 0
    buffer_load_dwordx4 v212, s[20:23], s31 offen offset:0  lds
    v_mfma_f32_16x16x32_bf16 v[100:103], a[20:23], v[188:191], v[100:103]
    v_cvt_pk_bf16_f32 v150, v140, v141
    v_cvt_pk_bf16_f32 v151, v142, v143
    v_mfma_f32_16x16x32_bf16 v[100:103], a[24:27], v[192:195], v[100:103]
    ds_read_b128 a[4:7], v201 offset:0
    v_mfma_f32_16x16x32_bf16 v[100:103], a[28:31], v[196:199], v[100:103]
    v_mfma_f32_16x16x32_bf16 v[32:35], a[32:35], v[148:151], v[32:35]
    buffer_load_dwordx4 v213, s[20:23], s31 offen offset:1024  lds
    v_mfma_f32_16x16x32_bf16 v[36:39], a[36:39], v[148:151], v[36:39]
    v_exp_f32 v96, v96
    v_mfma_f32_16x16x32_bf16 v[40:43], a[40:43], v[148:151], v[40:43]
    ds_read_b128 a[8:11], v202 offset:0
    ds_read_b128 a[12:15], v203 offset:0
    v_mfma_f32_16x16x32_bf16 v[44:47], a[44:47], v[148:151], v[44:47]
    v_exp_f32 v97, v97
    v_mfma_f32_16x16x32_bf16 v[48:51], a[48:51], v[148:151], v[48:51]
    ds_read_b128 a[16:19], v200 offset:1024
    v_cvt_pk_bf16_f32 v104, v96, v97
    v_mfma_f32_16x16x32_bf16 v[52:55], a[52:55], v[148:151], v[52:55]
    v_exp_f32 v98, v98
    v_mfma_f32_16x16x32_bf16 v[56:59], a[56:59], v[148:151], v[56:59]
    ds_read_b128 a[20:23], v201 offset:1024
    ds_read_b128 a[24:27], v202 offset:1024
    v_mfma_f32_16x16x32_bf16 v[60:63], a[60:63], v[148:151], v[60:63]
    v_exp_f32 v99, v99
    v_mfma_f32_16x16x32_bf16 a[92:95], a[104:107], v[148:151], a[92:95]
    s_waitcnt lgkmcnt(3)
    ds_read_b128 a[28:31], v203 offset:1024
    v_cvt_pk_bf16_f32 v105, v98, v99
    v_mfma_f32_16x16x32_bf16 v[128:131], a[0:3], v[152:155], 0
    s_add_u32 m0, s29, 32768
    v_exp_f32 v100, v100
    v_mfma_f32_16x16x32_bf16 v[128:131], a[4:7], v[156:159], v[128:131]
    buffer_load_dwordx4 v214, s[16:19], s32 offen offset:0  lds
    v_mfma_f32_16x16x32_bf16 v[128:131], a[8:11], v[160:163], v[128:131]
    v_exp_f32 v101, v101
    v_mfma_f32_16x16x32_bf16 v[128:131], a[12:15], v[164:167], v[128:131]
    s_waitcnt lgkmcnt(1)
    v_exp_f32 v102, v102
    v_mfma_f32_16x16x32_bf16 v[132:135], a[16:19], v[152:155], 0
    v_exp_f32 v103, v103
    v_mfma_f32_16x16x32_bf16 v[132:135], a[20:23], v[156:159], v[132:135]
    v_cvt_pk_bf16_f32 v106, v100, v101
    v_cvt_pk_bf16_f32 v107, v102, v103
    v_mfma_f32_16x16x32_bf16 v[132:135], a[24:27], v[160:163], v[132:135]
    s_waitcnt lgkmcnt(0)
    v_exp_f32 v128, v128
    v_mfma_f32_16x16x32_bf16 v[132:135], a[28:31], v[164:167], v[132:135]
    s_waitcnt vmcnt(14)
    buffer_load_dwordx4 v215, s[16:19], s32 offen offset:1024  lds
    v_mfma_f32_16x16x32_bf16 v[64:67], a[32:35], v[104:107], v[64:67]
    s_barrier
    ds_read_b64_tr_b16 a[32:33], v204 offset:8192
    v_mfma_f32_16x16x32_bf16 v[68:71], a[36:39], v[104:107], v[68:71]
    s_add_u32 s35, s35, 16384
    v_exp_f32 v129, v129
    v_mfma_f32_16x16x32_bf16 v[72:75], a[40:43], v[104:107], v[72:75]
    s_add_u32 s36, s36, 1056
    v_exp_f32 v130, v130
    v_mfma_f32_16x16x32_bf16 v[76:79], a[44:47], v[104:107], v[76:79]
    s_min_u32 s36, s36, s37
    ds_read_b64_tr_b16 a[34:35], v204 offset:9216
    v_cvt_pk_bf16_f32 v144, v128, v129
    v_mfma_f32_16x16x32_bf16 v[80:83], a[48:51], v[104:107], v[80:83]
    s_sub_u32 s89, s89, 1
    ds_read_b64_tr_b16 a[36:37], v205 offset:8192
    ds_read_b64_tr_b16 a[38:39], v205 offset:9216
    v_mfma_f32_16x16x32_bf16 v[84:87], a[52:55], v[104:107], v[84:87]
    s_cselect_b32 s35, s83, s35
    ds_read_b64_tr_b16 a[40:41], v206 offset:8192
    ds_read_b64_tr_b16 a[42:43], v206 offset:9216
    v_mfma_f32_16x16x32_bf16 v[88:91], a[56:59], v[104:107], v[88:91]
    s_cselect_b32 s36, s30, s36
    v_exp_f32 v131, v131
    v_mfma_f32_16x16x32_bf16 v[92:95], a[60:63], v[104:107], v[92:95]
    s_cselect_b32 s14, s87, s14
    ds_read_b64_tr_b16 a[44:45], v207 offset:8192
    ds_read_b64_tr_b16 a[46:47], v207 offset:9216
    v_mfma_f32_16x16x32_bf16 a[96:99], a[104:107], v[104:107], a[96:99]
    s_mov_b32 s31, s32
    ds_read_b64_tr_b16 a[48:49], v208 offset:8192
    v_cvt_pk_bf16_f32 v145, v130, v131
    v_mfma_f32_16x16x32_bf16 v[136:139], a[0:3], v[168:171], 0
    s_mov_b32 s22, s18
    v_exp_f32 v132, v132
    v_mfma_f32_16x16x32_bf16 v[136:139], a[4:7], v[172:175], v[136:139]
    s_sub_u32 s32, s32, 131072
    ds_read_b64_tr_b16 a[50:51], v208 offset:9216
    v_exp_f32 v133, v133
    v_mfma_f32_16x16x32_bf16 v[136:139], a[8:11], v[176:179], v[136:139]
    s_cmp_eq_u32 s32, s33
    ds_read_b64_tr_b16 a[52:53], v209 offset:8192
    v_cvt_pk_bf16_f32 v146, v132, v133
    v_mfma_f32_16x16x32_bf16 v[136:139], a[12:15], v[180:183], v[136:139]
    s_cselect_b32 s18, s34, s18
    ds_read_b64_tr_b16 a[54:55], v209 offset:9216
    ds_read_b64_tr_b16 a[56:57], v210 offset:8192
    v_mfma_f32_16x16x32_bf16 v[140:143], a[16:19], v[168:171], 0
    s_cselect_b64 s[32:33], s[80:81], s[32:33]
    v_exp_f32 v134, v134
    v_mfma_f32_16x16x32_bf16 v[140:143], a[20:23], v[172:175], v[140:143]
    s_sub_u32 s38, s38, 1
    v_exp_f32 v135, v135
    v_mfma_f32_16x16x32_bf16 v[140:143], a[24:27], v[176:179], v[140:143]
    ds_read_b64_tr_b16 a[58:59], v210 offset:9216
    v_cvt_pk_bf16_f32 v147, v134, v135
    v_mfma_f32_16x16x32_bf16 v[140:143], a[28:31], v[180:183], v[140:143]
    s_cbranch_scc1 L_ex3
L_body3_2:
    v_mfma_f32_16x16x32_bf16 a[88:91], a[104:107], v[144:147], a[88:91]
    s_waitcnt lgkmcnt(1)
    ds_read_b64_tr_b16 a[60:61], v211 offset:8192
    v_mfma_f32_16x16x32_bf16 v[0:3], a[32:35], v[144:147], v[0:3]
    s_mov_b32 s39, 24576
    ds_read_b64_tr_b16 a[62:63], v211 offset:9216
    v_mfma_f32_16x16x32_bf16 v[4:7], a[36:39], v[144:147], v[4:7]
    s_mov_b32 s42, 16384
    v_exp_f32 v136, v136
    v_mfma_f32_16x16x32_bf16 v[8:11], a[40:43], v[144:147], v[8:11]
    s_mov_b32 s43, 8192
    v_exp_f32 v137, v137
    v_mfma_f32_16x16x32_bf16 v[12:15], a[44:47], v[144:147], v[12:15]
    v_exp_f32 v138, v138
    v_mfma_f32_16x16x32_bf16 v[16:19], a[48:51], v[144:147], v[16:19]
    s_mov_b32 m0, s36
    v_exp_f32 v139, v139
    v_mfma_f32_16x16x32_bf16 v[20:23], a[52:55], v[144:147], v[20:23]
    s_waitcnt lgkmcnt(0)
    v_cvt_pk_bf16_f32 v148, v136, v137
    v_mfma_f32_16x16x32_bf16 v[24:27], a[56:59], v[144:147], v[24:27]
    buffer_load_dwordx4 v216, s[12:15], s35 offen offset:0 nt lds
    v_mfma_f32_16x16x32_bf16 v[28:31], a[60:63], v[144:147], v[28:31]
    v_exp_f32 v140, v140
    v_mfma_f32_16x16x32_bf16 v[96:99], a[0:3], v[184:187], 0
    v_exp_f32 v141, v141
    v_mfma_f32_16x16x32_bf16 v[96:99], a[4:7], v[188:191], v[96:99]
    v_exp_f32 v142, v142
    v_mfma_f32_16x16x32_bf16 v[96:99], a[8:11], v[192:195], v[96:99]
    ds_read_b128 a[0:3], v200 offset:8192
    v_cvt_pk_bf16_f32 v149, v138, v139
    v_mfma_f32_16x16x32_bf16 v[96:99], a[12:15], v[196:199], v[96:99]
    s_add_u32 m0, s29, 40960
    v_exp_f32 v143, v143
    v_mfma_f32_16x16x32_bf16 v[100:103], a[16:19], v[184:187], 0
    buffer_load_dwordx4 v212, s[20:23], s31 offen offset:0  lds
    v_mfma_f32_16x16x32_bf16 v[100:103], a[20:23], v[188:191], v[100:103]
    v_cvt_pk_bf16_f32 v150, v140, v141
    v_cvt_pk_bf16_f32 v151, v142, v143
    v_mfma_f32_16x16x32_bf16 v[100:103], a[24:27], v[192:195], v[100:103]
    ds_read_b128 a[4:7], v201 offset:8192
    v_mfma_f32_16x16x32_bf16 v[100:103], a[28:31], v[196:199], v[100:103]
    v_mfma_f32_16x16x32_bf16 v[32:35], a[32:35], v[148:151], v[32:35]
    buffer_load_dwordx4 v213, s[20:23], s31 offen offset:1024  lds
    v_mfma_f32_16x16x32_bf16 v[36:39], a[36:39], v[148:151], v[36:39]
    v_exp_f32 v96, v96
    v_mfma_f32_16x16x32_bf16 v[40:43], a[40:43], v[148:151], v[40:43]
    ds_read_b128 a[8:11], v202 offset:8192
    ds_read_b128 a[12:15], v203 offset:8192
    v_mfma_f32_16x16x32_bf16 v[44:47], a[44:47], v[148:151], v[44:47]
    v_exp_f32 v97, v97
    v_mfma_f32_16x16x32_bf16 v[48:51], a[48:51], v[148:151], v[48:51]
    ds_read_b128 a[16:19], v200 offset:9216
    v_cvt_pk_bf16_f32 v104, v96, v97
    v_mfma_f32_16x16x32_bf16 v[52:55], a[52:55], v[148:151], v[52:55]
    v_exp_f32 v98, v98
    v_mfma_f32_16x16x32_bf16 v[56:59], a[56:59], v[148:151], v[56:59]
    ds_read_b128 a[20:23], v201 offset:9216
    ds_read_b128 a[24:27], v202 offset:9216
    v_mfma_f32_16x16x32_bf16 v[60:63], a[60:63], v[148:151], v[60:63]
    v_exp_f32 v99, v99
    v_mfma_f32_16x16x32_bf16 a[92:95], a[104:107], v[148:151], a[92:95]
    s_waitcnt lgkmcnt(3)
    ds_read_b128 a[28:31], v203 offset:9216
    v_cvt_pk_bf16_f32 v105, v98, v99
    v_mfma_f32_16x16x32_bf16 v[128:131], a[0:3], v[152:155], 0
    s_add_u32 m0, s29, 0
    v_exp_f32 v100, v100
    v_mfma_f32_16x16x32_bf16 v[128:131], a[4:7], v[156:159], v[128:131]
    buffer_load_dwordx4 v214, s[16:19], s32 offen offset:0  lds
    v_mfma_f32_16x16x32_bf16 v[128:131], a[8:11], v[160:163], v[128:131]
    v_exp_f32 v101, v101
    v_mfma_f32_16x16x32_bf16 v[128:131], a[12:15], v[164:167], v[128:131]
    s_waitcnt lgkmcnt(1)
    v_exp_f32 v102, v102
    v_mfma_f32_16x16x32_bf16 v[132:135], a[16:19], v[152:155], 0
    v_exp_f32 v103, v103
    v_mfma_f32_16x16x32_bf16 v[132:135], a[20:23], v[156:159], v[132:135]
    v_cvt_pk_bf16_f32 v106, v100, v101
    v_cvt_pk_bf16_f32 v107, v102, v103
    v_mfma_f32_16x16x32_bf16 v[132:135], a[24:27], v[160:163], v[132:135]
    s_waitcnt lgkmcnt(0)
    v_exp_f32 v128, v128
    v_mfma_f32_16x16x32_bf16 v[132:135], a[28:31], v[164:167], v[132:135]
    s_waitcnt vmcnt(14)
    buffer_load_dwordx4 v215, s[16:19], s32 offen offset:1024  lds
    v_mfma_f32_16x16x32_bf16 v[64:67], a[32:35], v[104:107], v[64:67]
    s_barrier
    ds_read_b64_tr_b16 a[32:33], v204 offset:16384
    v_mfma_f32_16x16x32_bf16 v[68:71], a[36:39], v[104:107], v[68:71]
    s_add_u32 s35, s35, 16384
    v_exp_f32 v129, v129
    v_mfma_f32_16x16x32_bf16 v[72:75], a[40:43], v[104:107], v[72:75]
    s_add_u32 s36, s36, 1056
    v_exp_f32 v130, v130
    v_mfma_f32_16x16x32_bf16 v[76:79], a[44:47], v[104:107], v[76:79]
    s_min_u32 s36, s36, s37
    ds_read_b64_tr_b16 a[34:35], v204 offset:17408
    v_cvt_pk_bf16_f32 v144, v128, v129
    v_mfma_f32_16x16x32_bf16 v[80:83], a[48:51], v[104:107], v[80:83]
    s_sub_u32 s89, s89, 1
    ds_read_b64_tr_b16 a[36:37], v205 offset:16384
    ds_read_b64_tr_b16 a[38:39], v205 offset:17408
    v_mfma_f32_16x16x32_bf16 v[84:87], a[52:55], v[104:107], v[84:87]
    s_cselect_b32 s35, s83, s35
    ds_read_b64_tr_b16 a[40:41], v206 offset:16384
    ds_read_b64_tr_b16 a[42:43], v206 offset:17408
    v_mfma_f32_16x16x32_bf16 v[88:91], a[56:59], v[104:107], v[88:91]
    s_cselect_b32 s36, s30, s36
    v_exp_f32 v131, v131
    v_mfma_f32_16x16x32_bf16 v[92:95], a[60:63], v[104:107], v[92:95]
    s_cselect_b32 s14, s87, s14
    ds_read_b64_tr_b16 a[44:45], v207 offset:16384
    ds_read_b64_tr_b16 a[46:47], v207 offset:17408
    v_mfma_f32_16x16x32_bf16 a[96:99], a[104:107], v[104:107], a[96:99]
    s_mov_b32 s31, s32
    ds_read_b64_tr_b16 a[48:49], v208 offset:16384
    v_cvt_pk_bf16_f32 v145, v130, v131
    v_mfma_f32_16x16x32_bf16 v[136:139], a[0:3], v[168:171], 0
    s_mov_b32 s22, s18
    v_exp_f32 v132, v132
    v_mfma_f32_16x16x32_bf16 v[136:139], a[4:7], v[172:175], v[136:139]
    s_sub_u32 s32, s32, 131072
    ds_read_b64_tr_b16 a[50:51], v208 offset:17408
    v_exp_f32 v133, v133
    v_mfma_f32_16x16x32_bf16 v[136:139], a[8:11], v[176:179], v[136:139]
    s_cmp_eq_u32 s32, s33
    ds_read_b64_tr_b16 a[52:53], v209 offset:16384
    v_cvt_pk_bf16_f32 v146, v132, v133
    v_mfma_f32_16x16x32_bf16 v[136:139], a[12:15], v[180:183], v[136:139]
    s_cselect_b32 s18, s34, s18
    ds_read_b64_tr_b16 a[54:55], v209 offset:17408
    ds_read_b64_tr_b16 a[56:57], v210 offset:16384
    v_mfma_f32_16x16x32_bf16 v[140:143], a[16:19], v[168:171], 0
    s_cselect_b64 s[32:33], s[80:81], s[32:33]
    v_exp_f32 v134, v134
    v_mfma_f32_16x16x32_bf16 v[140:143], a[20:23], v[172:175], v[140:143]
    s_sub_u32 s38, s38, 1
    v_exp_f32 v135, v135
    v_mfma_f32_16x16x32_bf16 v[140:143], a[24:27], v[176:179], v[140:143]
    ds_read_b64_tr_b16 a[58:59], v210 offset:17408
    v_cvt_pk_bf16_f32 v147, v134, v135
    v_mfma_f32_16x16x32_bf16 v[140:143], a[28:31], v[180:183], v[140:143]
    s_cbranch_scc1 L_ex3
L_body3_3:
    v_mfma_f32_16x16x32_bf16 a[88:91], a[104:107], v[144:147], a[88:91]
    s_waitcnt lgkmcnt(1)
    ds_read_b64_tr_b16 a[60:61], v211 offset:16384
    v_mfma_f32_16x16x32_bf16 v[0:3], a[32:35], v[144:147], v[0:3]
    s_mov_b32 s39, 32768
    ds_read_b64_tr_b16 a[62:63], v211 offset:17408
    v_mfma_f32_16x16x32_bf16 v[4:7], a[36:39], v[144:147], v[4:7]
    s_mov_b32 s42, 24576
    v_exp_f32 v136, v136
    v_mfma_f32_16x16x32_bf16 v[8:11], a[40:43], v[144:147], v[8:11]
    s_mov_b32 s43, 16384
    v_exp_f32 v137, v137
    v_mfma_f32_16x16x32_bf16 v[12:15], a[44:47], v[144:147], v[12:15]
    v_exp_f32 v138, v138
    v_mfma_f32_16x16x32_bf16 v[16:19], a[48:51], v[144:147], v[16:19]
    s_mov_b32 m0, s36
    v_exp_f32 v139, v139
    v_mfma_f32_16x16x32_bf16 v[20:23], a[52:55], v[144:147], v[20:23]
    s_waitcnt lgkmcnt(0)
    v_cvt_pk_bf16_f32 v148, v136, v137
    v_mfma_f32_16x16x32_bf16 v[24:27], a[56:59], v[144:147], v[24:27]
    buffer_load_dwordx4 v216, s[12:15], s35 offen offset:0 nt lds
    v_mfma_f32_16x16x32_bf16 v[28:31], a[60:63], v[144:147], v[28:31]
    v_exp_f32 v140, v140
    v_mfma_f32_16x16x32_bf16 v[96:99], a[0:3], v[184:187], 0
    v_exp_f32 v141, v141
    v_mfma_f32_16x16x32_bf16 v[96:99], a[4:7], v[188:191], v[96:99]
    v_exp_f32 v142, v142
    v_mfma_f32_16x16x32_bf16 v[96:99], a[8:11], v[192:195], v[96:99]
    ds_read_b128 a[0:3], v200 offset:16384
    v_cvt_pk_bf16_f32 v149, v138, v139
    v_mfma_f32_16x16x32_bf16 v[96:99], a[12:15], v[196:199], v[96:99]
    s_add_u32 m0, s29, 49152
    v_exp_f32 v143, v143
    v_mfma_f32_16x16x32_bf16 v[100:103], a[16:19], v[184:187], 0
    buffer_load_dwordx4 v212, s[20:23], s31 offen offset:0  lds
    v_mfma_f32_16x16x32_bf16 v[100:103], a[20:23], v[188:191], v[100:103]
    v_cvt_pk_bf16_f32 v150, v140, v141
    v_cvt_pk_bf16_f32 v151, v142, v143
    v_mfma_f32_16x16x32_bf16 v[100:103], a[24:27], v[192:195], v[100:103]
    ds_read_b128 a[4:7], v201 offset:16384
    v_mfma_f32_16x16x32_bf16 v[100:103], a[28:31], v[196:199], v[100:103]
    v_mfma_f32_16x16x32_bf16 v[32:35], a[32:35], v[148:151], v[32:35]
    buffer_load_dwordx4 v213, s[20:23], s31 offen offset:1024  lds
    v_mfma_f32_16x16x32_bf16 v[36:39], a[36:39], v[148:151], v[36:39]
    v_exp_f32 v96, v96
    v_mfma_f32_16x16x32_bf16 v[40:43], a[40:43], v[148:151], v[40:43]
    ds_read_b128 a[8:11], v202 offset:16384
    ds_read_b128 a[12:15], v203 offset:16384
    v_mfma_f32_16x16x32_bf16 v[44:47], a[44:47], v[148:151], v[44:47]
    v_exp_f32 v97, v97
    v_mfma_f32_16x16x32_bf16 v[48:51], a[48:51], v[148:151], v[48:51]
    ds_read_b128 a[16:19], v200 offset:17408
    v_cvt_pk_bf16_f32 v104, v96, v97
    v_mfma_f32_16x16x32_bf16 v[52:55], a[52:55], v[148:151], v[52:55]
    v_exp_f32 v98, v98
    v_mfma_f32_16x16x32_bf16 v[56:59], a[56:59], v[148:151], v[56:59]
    ds_read_b128 a[20:23], v201 offset:17408
    ds_read_b128 a[24:27], v202 offset:17408
    v_mfma_f32_16x16x32_bf16 v[60:63], a[60:63], v[148:151], v[60:63]
    v_exp_f32 v99, v99
    v_mfma_f32_16x16x32_bf16 a[92:95], a[104:107], v[148:151], a[92:95]
    s_waitcnt lgkmcnt(3)
    ds_read_b128 a[28:31], v203 offset:17408
    v_cvt_pk_bf16_f32 v105, v98, v99
    v_mfma_f32_16x16x32_bf16 v[128:131], a[0:3], v[152:155], 0
    s_add_u32 m0, s29, 8192
    v_exp_f32 v100, v100
    v_mfma_f32_16x16x32_bf16 v[128:131], a[4:7], v[156:159], v[128:131]
    buffer_load_dwordx4 v214, s[16:19], s32 offen offset:0  lds
    v_mfma_f32_16x16x32_bf16 v[128:131], a[8:11], v[160:163], v[128:131]
    v_exp_f32 v101, v101
    v_mfma_f32_16x16x32_bf16 v[128:131], a[12:15], v[164:167], v[128:131]
    s_waitcnt lgkmcnt(1)
    v_exp_f32 v102, v102
    v_mfma_f32_16x16x32_bf16 v[132:135], a[16:19], v[152:155], 0
    v_exp_f32 v103, v103
    v_mfma_f32_16x16x32_bf16 v[132:135], a[20:23], v[156:159], v[132:135]
    v_cvt_pk_bf16_f32 v106, v100, v101
    v_cvt_pk_bf16_f32 v107, v102, v103
    v_mfma_f32_16x16x32_bf16 v[132:135], a[24:27], v[160:163], v[132:135]
    s_waitcnt lgkmcnt(0)
    v_exp_f32 v128, v128
    v_mfma_f32_16x16x32_bf16 v[132:135], a[28:31], v[164:167], v[132:135]
    s_waitcnt vmcnt(14)
    buffer_load_dwordx4 v215, s[16:19], s32 offen offset:1024  lds
    v_mfma_f32_16x16x32_bf16 v[64:67], a[32:35], v[104:107], v[64:67]
    s_barrier
    ds_read_b64_tr_b16 a[32:33], v204 offset:24576
    v_mfma_f32_16x16x32_bf16 v[68:71], a[36:39], v[104:107], v[68:71]
    s_add_u32 s35, s35, 16384
    v_exp_f32 v129, v129
    v_mfma_f32_16x16x32_bf16 v[72:75], a[40:43], v[104:107], v[72:75]
    s_add_u32 s36, s36, 1056
    v_exp_f32 v130, v130
    v_mfma_f32_16x16x32_bf16 v[76:79], a[44:47], v[104:107], v[76:79]
    s_min_u32 s36, s36, s37
    ds_read_b64_tr_b16 a[34:35], v204 offset:25600
    v_cvt_pk_bf16_f32 v144, v128, v129
    v_mfma_f32_16x16x32_bf16 v[80:83], a[48:51], v[104:107], v[80:83]
    s_sub_u32 s89, s89, 1
    ds_read_b64_tr_b16 a[36:37], v205 offset:24576
    ds_read_b64_tr_b16 a[38:39], v205 offset:25600
    v_mfma_f32_16x16x32_bf16 v[84:87], a[52:55], v[104:107], v[84:87]
    s_cselect_b32 s35, s83, s35
    ds_read_b64_tr_b16 a[40:41], v206 offset:24576
    ds_read_b64_tr_b16 a[42:43], v206 offset:25600
    v_mfma_f32_16x16x32_bf16 v[88:91], a[56:59], v[104:107], v[88:91]
    s_cselect_b32 s36, s30, s36
    v_exp_f32 v131, v131
    v_mfma_f32_16x16x32_bf16 v[92:95], a[60:63], v[104:107], v[92:95]
    s_cselect_b32 s14, s87, s14
    ds_read_b64_tr_b16 a[44:45], v207 offset:24576
    ds_read_b64_tr_b16 a[46:47], v207 offset:25600
    v_mfma_f32_16x16x32_bf16 a[96:99], a[104:107], v[104:107], a[96:99]
    s_mov_b32 s31, s32
    ds_read_b64_tr_b16 a[48:49], v208 offset:24576
    v_cvt_pk_bf16_f32 v145, v130, v131
    v_mfma_f32_16x16x32_bf16 v[136:139], a[0:3], v[168:171], 0
    s_mov_b32 s22, s18
    v_exp_f32 v132, v132
    v_mfma_f32_16x16x32_bf16 v[136:139], a[4:7], v[172:175], v[136:139]
    s_sub_u32 s32, s32, 131072
    ds_read_b64_tr_b16 a[50:51], v208 offset:25600
    v_exp_f32 v133, v133
    v_mfma_f32_16x16x32_bf16 v[136:139], a[8:11], v[176:179], v[136:139]
    s_cmp_eq_u32 s32, s33
    ds_read_b64_tr_b16 a[52:53], v209 offset:24576
    v_cvt_pk_bf16_f32 v146, v132, v133
    v_mfma_f32_16x16x32_bf16 v[136:139], a[12:15], v[180:183], v[136:139]
    s_cselect_b32 s18, s34, s18
    ds_read_b64_tr_b16 a[54:55], v209 offset:25600
    ds_read_b64_tr_b16 a[56:57], v210 offset:24576
    v_mfma_f32_16x16x32_bf16 v[140:143], a[16:19], v[168:171], 0
    s_cselect_b64 s[32:33], s[80:81], s[32:33]
    v_exp_f32 v134, v134
    v_mfma_f32_16x16x32_bf16 v[140:143], a[20:23], v[172:175], v[140:143]
    s_sub_u32 s38, s38, 1
    v_exp_f32 v135, v135
    v_mfma_f32_16x16x32_bf16 v[140:143], a[24:27], v[176:179], v[140:143]
    ds_read_b64_tr_b16 a[58:59], v210 offset:25600
    v_cvt_pk_bf16_f32 v147, v134, v135
    v_mfma_f32_16x16x32_bf16 v[140:143], a[28:31], v[180:183], v[140:143]
    s_cbranch_scc1 L_ex3
L_body3_4:
    v_mfma_f32_16x16x32_bf16 a[88:91], a[104:107], v[144:147], a[88:91]
    s_waitcnt lgkmcnt(1)
    ds_read_b64_tr_b16 a[60:61], v211 offset:24576
    v_mfma_f32_16x16x32_bf16 v[0:3], a[32:35], v[144:147], v[0:3]
    s_mov_b32 s39, 0
    ds_read_b64_tr_b16 a[62:63], v211 offset:25600
    v_mfma_f32_16x16x32_bf16 v[4:7], a[36:39], v[144:147], v[4:7]
    s_mov_b32 s42, 32768
    v_exp_f32 v136, v136
    v_mfma_f32_16x16x32_bf16 v[8:11], a[40:43], v[144:147], v[8:11]
    s_mov_b32 s43, 24576
    v_exp_f32 v137, v137
    v_mfma_f32_16x16x32_bf16 v[12:15], a[44:47], v[144:147], v[12:15]
    v_exp_f32 v138, v138
    v_mfma_f32_16x16x32_bf16 v[16:19], a[48:51], v[144:147], v[16:19]
    s_mov_b32 m0, s36
    v_exp_f32 v139, v139
    v_mfma_f32_16x16x32_bf16 v[20:23], a[52:55], v[144:147], v[20:23]
    s_waitcnt lgkmcnt(0)
    v_cvt_pk_bf16_f32 v148, v136, v137
    v_mfma_f32_16x16x32_bf16 v[24:27], a[56:59], v[144:147], v[24:27]
    buffer_load_dwordx4 v216, s[12:15], s35 offen offset:0 nt lds
    v_mfma_f32_16x16x32_bf16 v[28:31], a[60:63], v[144:147], v[28:31]
    v_exp_f32 v140, v140
    v_mfma_f32_16x16x32_bf16 v[96:99], a[0:3], v[184:187], 0
    v_exp_f32 v141, v141
    v_mfma_f32_16x16x32_bf16 v[96:99], a[4:7], v[188:191], v[96:99]
    v_exp_f32 v142, v142
    v_mfma_f32_16x16x32_bf16 v[96:99], a[8:11], v[192:195], v[96:99]
    ds_read_b128 a[0:3], v200 offset:24576
    v_cvt_pk_bf16_f32 v149, v138, v139
    v_mfma_f32_16x16x32_bf16 v[96:99], a[12:15], v[196:199], v[96:99]
    s_add_u32 m0, s29, 57344
    v_exp_f32 v143, v143
    v_mfma_f32_16x16x32_bf16 v[100:103], a[16:19], v[184:187], 0
    buffer_load_dwordx4 v212, s[20:23], s31 offen offset:0  lds
    v_mfma_f32_16x16x32_bf16 v[100:103], a[20:23], v[188:191], v[100:103]
    v_cvt_pk_bf16_f32 v150, v140, v141
    v_cvt_pk_bf16_f32 v151, v142, v143
    v_mfma_f32_16x16x32_bf16 v[100:103], a[24:27], v[192:195], v[100:103]
    ds_read_b128 a[4:7], v201 offset:24576
    v_mfma_f32_16x16x32_bf16 v[100:103], a[28:31], v[196:199], v[100:103]
    v_mfma_f32_16x16x32_bf16 v[32:35], a[32:35], v[148:151], v[32:35]
    buffer_load_dwordx4 v213, s[20:23], s31 offen offset:1024  lds
    v_mfma_f32_16x16x32_bf16 v[36:39], a[36:39], v[148:151], v[36:39]
    v_exp_f32 v96, v96
    v_mfma_f32_16x16x32_bf16 v[40:43], a[40:43], v[148:151], v[40:43]
    ds_read_b128 a[8:11], v202 offset:24576
    ds_read_b128 a[12:15], v203 offset:24576
    v_mfma_f32_16x16x32_bf16 v[44:47], a[44:47], v[148:151], v[44:47]
    v_exp_f32 v97, v97
    v_mfma_f32_16x16x32_bf16 v[48:51], a[48:51], v[148:151], v[48:51]
    ds_read_b128 a[16:19], v200 offset:25600
    v_cvt_pk_bf16_f32 v104, v96, v97
    v_mfma_f32_16x16x32_bf16 v[52:55], a[52:55], v[148:151], v[52:55]
    v_exp_f32 v98, v98
    v_mfma_f32_16x16x32_bf16 v[56:59], a[56:59], v[148:151], v[56:59]
    ds_read_b128 a[20:23], v201 offset:25600
    ds_read_b128 a[24:27], v202 offset:25600
    v_mfma_f32_16x16x32_bf16 v[60:63], a[60:63], v[148:151], v[60:63]
    v_exp_f32 v99, v99
    v_mfma_f32_16x16x32_bf16 a[92:95], a[104:107], v[148:151], a[92:95]
    s_waitcnt lgkmcnt(3)
    ds_read_b128 a[28:31], v203 offset:25600
    v_cvt_pk_bf16_f32 v105, v98, v99
    v_mfma_f32_16x16x32_bf16 v[128:131], a[0:3], v[152:155], 0
    s_add_u32 m0, s29, 16384
    v_exp_f32 v100, v100
    v_mfma_f32_16x16x32_bf16 v[128:131], a[4:7], v[156:159], v[128:131]
    buffer_load_dwordx4 v214, s[16:19], s32 offen offset:0  lds
    v_mfma_f32_16x16x32_bf16 v[128:131], a[8:11], v[160:163], v[128:131]
    v_exp_f32 v101, v101
    v_mfma_f32_16x16x32_bf16 v[128:131], a[12:15], v[164:167], v[128:131]
    s_waitcnt lgkmcnt(1)
    v_exp_f32 v102, v102
    v_mfma_f32_16x16x32_bf16 v[132:135], a[16:19], v[152:155], 0
    v_exp_f32 v103, v103
    v_mfma_f32_16x16x32_bf16 v[132:135], a[20:23], v[156:159], v[132:135]
    v_cvt_pk_bf16_f32 v106, v100, v101
    v_cvt_pk_bf16_f32 v107, v102, v103
    v_mfma_f32_16x16x32_bf16 v[132:135], a[24:27], v[160:163], v[132:135]
    s_waitcnt lgkmcnt(0)
    v_exp_f32 v128, v128
    v_mfma_f32_16x16x32_bf16 v[132:135], a[28:31], v[164:167], v[132:135]
    s_waitcnt vmcnt(14)
    buffer_load_dwordx4 v215, s[16:19], s32 offen offset:1024  lds
    v_mfma_f32_16x16x32_bf16 v[64:67], a[32:35], v[104:107], v[64:67]
    s_barrier
    ds_read_b64_tr_b16 a[32:33], v204 offset:32768
    v_mfma_f32_16x16x32_bf16 v[68:71], a[36:39], v[104:107], v[68:71]
    s_add_u32 s35, s35, 16384
    v_exp_f32 v129, v129
    v_mfma_f32_16x16x32_bf16 v[72:75], a[40:43], v[104:107], v[72:75]
    s_add_u32 s36, s36, 1056
    v_exp_f32 v130, v130
    v_mfma_f32_16x16x32_bf16 v[76:79], a[44:47], v[104:107], v[76:79]
    s_min_u32 s36, s36, s37
    ds_read_b64_tr_b16 a[34:35], v204 offset:33792
    v_cvt_pk_bf16_f32 v144, v128, v129
    v_mfma_f32_16x16x32_bf16 v[80:83], a[48:51], v[104:107], v[80:83]
    s_sub_u32 s89, s89, 1
    ds_read_b64_tr_b16 a[36:37], v205 offset:32768
    ds_read_b64_tr_b16 a[38:39], v205 offset:33792
    v_mfma_f32_16x16x32_bf16 v[84:87], a[52:55], v[104:107], v[84:87]
    s_cselect_b32 s35, s83, s35
    ds_read_b64_tr_b16 a[40:41], v206 offset:32768
    ds_read_b64_tr_b16 a[42:43], v206 offset:33792
    v_mfma_f32_16x16x32_bf16 v[88:91], a[56:59], v[104:107], v[88:91]
    s_cselect_b32 s36, s30, s36
    v_exp_f32 v131, v131
    v_mfma_f32_16x16x32_bf16 v[92:95], a[60:63], v[104:107], v[92:95]
    s_cselect_b32 s14, s87, s14
    ds_read_b64_tr_b16 a[44:45], v207 offset:32768
    ds_read_b64_tr_b16 a[46:47], v207 offset:33792
    v_mfma_f32_16x16x32_bf16 a[96:99], a[104:107], v[104:107], a[96:99]
    s_mov_b32 s31, s32
    ds_read_b64_tr_b16 a[48:49], v208 offset:32768
    v_cvt_pk_bf16_f32 v145, v130, v131
    v_mfma_f32_16x16x32_bf16 v[136:139], a[0:3], v[168:171], 0
    s_mov_b32 s22, s18
    v_exp_f32 v132, v132
    v_mfma_f32_16x16x32_bf16 v[136:139], a[4:7], v[172:175], v[136:139]
    s_sub_u32 s32, s32, 131072
    ds_read_b64_tr_b16 a[50:51], v208 offset:33792
    v_exp_f32 v133, v133
    v_mfma_f32_16x16x32_bf16 v[136:139], a[8:11], v[176:179], v[136:139]
    s_cmp_eq_u32 s32, s33
    ds_read_b64_tr_b16 a[52:53], v209 offset:32768
    v_cvt_pk_bf16_f32 v146, v132, v133
    v_mfma_f32_16x16x32_bf16 v[136:139], a[12:15], v[180:183], v[136:139]
    s_cselect_b32 s18, s34, s18
    ds_read_b64_tr_b16 a[54:55], v209 offset:33792
    ds_read_b64_tr_b16 a[56:57], v210 offset:32768
    v_mfma_f32_16x16x32_bf16 v[140:143], a[16:19], v[168:171], 0
    s_cselect_b64 s[32:33], s[80:81], s[32:33]
    v_exp_f32 v134, v134
    v_mfma_f32_16x16x32_bf16 v[140:143], a[20:23], v[172:175], v[140:143]
    s_sub_u32 s38, s38, 1
    v_exp_f32 v135, v135
    v_mfma_f32_16x16x32_bf16 v[140:143], a[24:27], v[176:179], v[140:143]
    ds_read_b64_tr_b16 a[58:59], v210 offset:33792
    v_cvt_pk_bf16_f32 v147, v134, v135
    v_mfma_f32_16x16x32_bf16 v[140:143], a[28:31], v[180:183], v[140:143]
    s_cbranch_scc0 L_body3_0
L_ex3:
    s_cmp_lg_u32 s88, 0
    s_cbranch_scc1 L_ev
L_last3:
    v_add_u32 v239, s42, v211
    v_mfma_f32_16x16x32_bf16 a[88:91], a[104:107], v[144:147], a[88:91]
    s_waitcnt lgkmcnt(1)
    ds_read_b64_tr_b16 a[60:61], v239 offset:0
    ds_read_b64_tr_b16 a[62:63], v239 offset:1024
    v_mfma_f32_16x16x32_bf16 v[0:3], a[32:35], v[144:147], v[0:3]
    s_mov_b32 s44, s50
    v_exp_f32 v136, v136
    v_mfma_f32_16x16x32_bf16 v[4:7], a[36:39], v[144:147], v[4:7]
    s_mov_b32 s26, s53
    v_mfma_f32_16x16x32_bf16 v[8:11], a[40:43], v[144:147], v[8:11]
    s_mov_b64 s[48:49], 0
    v_exp_f32 v137, v137
    v_mfma_f32_16x16x32_bf16 v[12:15], a[44:47], v[144:147], v[12:15]
    s_add_u32 s58, s43, s29
    v_cvt_pk_bf16_f32 v148, v136, v137
    v_mfma_f32_16x16x32_bf16 v[16:19], a[48:51], v[144:147], v[16:19]
    s_mov_b32 m0, s36
    v_exp_f32 v138, v138
    v_mfma_f32_16x16x32_bf16 v[20:23], a[52:55], v[144:147], v[20:23]
    s_waitcnt lgkmcnt(0)
    v_mfma_f32_16x16x32_bf16 v[24:27], a[56:59], v[144:147], v[24:27]
    v_exp_f32 v139, v139
    v_mfma_f32_16x16x32_bf16 v[28:31], a[60:63], v[144:147], v[28:31]
    v_cvt_pk_bf16_f32 v149, v138, v139
    v_mfma_f32_16x16x32_bf16 v[96:99], a[0:3], v[184:187], 0
    v_exp_f32 v140, v140
    v_mfma_f32_16x16x32_bf16 v[96:99], a[4:7], v[188:191], v[96:99]
    v_mfma_f32_16x16x32_bf16 v[96:99], a[8:11], v[192:195], v[96:99]
    v_exp_f32 v141, v141
    v_mfma_f32_16x16x32_bf16 v[96:99], a[12:15], v[196:199], v[96:99]
    v_cvt_pk_bf16_f32 v150, v140, v141
    v_mfma_f32_16x16x32_bf16 v[100:103], a[16:19], v[184:187], 0
    v_exp_f32 v142, v142
    v_mfma_f32_16x16x32_bf16 v[100:103], a[20:23], v[188:191], v[100:103]
    v_exp_f32 v143, v143
    v_mfma_f32_16x16x32_bf16 v[100:103], a[24:27], v[192:195], v[100:103]
    v_cvt_pk_bf16_f32 v151, v142, v143
    v_mfma_f32_16x16x32_bf16 v[100:103], a[28:31], v[196:199], v[100:103]
    v_exp_f32 v96, v96
    v_mfma_f32_16x16x32_bf16 v[32:35], a[32:35], v[148:151], v[32:35]
    v_exp_f32 v97, v97
    v_mfma_f32_16x16x32_bf16 v[36:39], a[36:39], v[148:151], v[36:39]
    v_exp_f32 v98, v98
    v_mfma_f32_16x16x32_bf16 v[40:43], a[40:43], v[148:151], v[40:43]
    v_exp_f32 v99, v99
    v_mfma_f32_16x16x32_bf16 v[44:47], a[44:47], v[148:151], v[44:47]
    v_cvt_pk_bf16_f32 v104, v96, v97
    v_cvt_pk_bf16_f32 v105, v98, v99
    v_mfma_f32_16x16x32_bf16 v[48:51], a[48:51], v[148:151], v[48:51]
    v_exp_f32 v100, v100
    v_mfma_f32_16x16x32_bf16 v[52:55], a[52:55], v[148:151], v[52:55]
    v_exp_f32 v101, v101
    v_mfma_f32_16x16x32_bf16 v[56:59], a[56:59], v[148:151], v[56:59]
    v_exp_f32 v102, v102
    v_mfma_f32_16x16x32_bf16 v[60:63], a[60:63], v[148:151], v[60:63]
    v_exp_f32 v103, v103
    v_mfma_f32_16x16x32_bf16 a[92:95], a[104:107], v[148:151], a[92:95]
    s_waitcnt vmcnt(9)
    v_cvt_pk_bf16_f32 v106, v100, v101
    v_cvt_pk_bf16_f32 v107, v102, v103
    s_cmp_eq_u32 s82, 0
    s_cbranch_scc0 L_trans3
L_fin3:
    v_accvgpr_read_b32 v250, a88
    v_rcp_f32 v248, v250
    v_subrev_u32 v250, s51, v250
    v_cmp_le_u32 vcc, s52, v250
    v_pk_mul_f32 v[0:1], v[0:1], v[248:249] op_sel_hi:[1,0]
    v_pk_mul_f32 v[2:3], v[2:3], v[248:249] op_sel_hi:[1,0]
    v_pk_mul_f32 v[4:5], v[4:5], v[248:249] op_sel_hi:[1,0]
    v_pk_mul_f32 v[6:7], v[6:7], v[248:249] op_sel_hi:[1,0]
    v_pk_mul_f32 v[8:9], v[8:9], v[248:249] op_sel_hi:[1,0]
    v_pk_mul_f32 v[10:11], v[10:11], v[248:249] op_sel_hi:[1,0]
    v_pk_mul_f32 v[12:13], v[12:13], v[248:249] op_sel_hi:[1,0]
    v_pk_mul_f32 v[14:15], v[14:15], v[248:249] op_sel_hi:[1,0]
    v_pk_mul_f32 v[16:17], v[16:17], v[248:249] op_sel_hi:[1,0]
    v_pk_mul_f32 v[18:19], v[18:19], v[248:249] op_sel_hi:[1,0]
    v_pk_mul_f32 v[20:21], v[20:21], v[248:249] op_sel_hi:[1,0]
    v_pk_mul_f32 v[22:23], v[22:23], v[248:249] op_sel_hi:[1,0]
    v_pk_mul_f32 v[24:25], v[24:25], v[248:249] op_sel_hi:[1,0]
    v_pk_mul_f32 v[26:27], v[26:27], v[248:249] op_sel_hi:[1,0]
    v_pk_mul_f32 v[28:29], v[28:29], v[248:249] op_sel_hi:[1,0]
    v_pk_mul_f32 v[30:31], v[30:31], v[248:249] op_sel_hi:[1,0]
    v_cvt_pk_bf16_f32 v184, v0, v4
    v_cvt_pk_bf16_f32 v185, v8, v12
    v_cvt_pk_bf16_f32 v186, v16, v20
    v_cvt_pk_bf16_f32 v187, v24, v28
    v_cvt_pk_bf16_f32 v188, v1, v5
    v_cvt_pk_bf16_f32 v189, v9, v13
    v_cvt_pk_bf16_f32 v190, v17, v21
    v_cvt_pk_bf16_f32 v191, v25, v29
    v_mfma_f32_16x16x32_bf16 v[152:155], v[184:187], a[64:67], 0
    s_or_b64 s[48:49], s[48:49], vcc
    v_cvt_pk_bf16_f32 v192, v2, v6
    v_cvt_pk_bf16_f32 v193, v10, v14
    v_mfma_f32_16x16x32_bf16 v[168:171], v[184:187], a[68:71], 0
    v_cvt_pk_bf16_f32 v194, v18, v22
    v_cvt_pk_bf16_f32 v195, v26, v30
    v_mfma_f32_16x16x32_bf16 v[156:159], v[188:191], a[64:67], 0
    v_cvt_pk_bf16_f32 v196, v3, v7
    v_cvt_pk_bf16_f32 v197, v11, v15
    v_mfma_f32_16x16x32_bf16 v[172:175], v[188:191], a[68:71], 0
    v_cvt_pk_bf16_f32 v198, v19, v23
    v_cvt_pk_bf16_f32 v199, v27, v31
    v_mfma_f32_16x16x32_bf16 v[160:163], v[192:195], a[64:67], 0
    s_nop 0
    v_mfma_f32_16x16x32_bf16 v[176:179], v[192:195], a[68:71], 0
    s_nop 0
    v_mfma_f32_16x16x32_bf16 v[164:167], v[196:199], a[64:67], 0
    v_cvt_pk_bf16_f32 v0, v152, v156
    v_cvt_pk_bf16_f32 v4, v153, v157
    v_mfma_f32_16x16x32_bf16 v[180:183], v[196:199], a[68:71], 0
    v_cvt_pk_bf16_f32 v8, v154, v158
    v_cvt_pk_bf16_f32 v12, v155, v159
    v_cvt_pk_bf16_f32 v2, v168, v172
    v_cvt_pk_bf16_f32 v6, v169, v173
    v_cvt_pk_bf16_f32 v10, v170, v174
    v_cvt_pk_bf16_f32 v14, v171, v175
    v_cvt_pk_bf16_f32 v1, v160, v164
    v_cvt_pk_bf16_f32 v5, v161, v165
    v_cvt_pk_bf16_f32 v3, v176, v180
    v_cvt_pk_bf16_f32 v9, v162, v166
    v_cvt_pk_bf16_f32 v7, v177, v181
    v_cvt_pk_bf16_f32 v13, v163, v167
    v_cvt_pk_bf16_f32 v11, v178, v182
    v_cvt_pk_bf16_f32 v15, v179, v183
    buffer_store_dwordx4 v[0:3], v223, s[24:27], s44 offen sc1
    v_accvgpr_read_b32 v250, a92
    v_rcp_f32 v248, v250
    v_subrev_u32 v250, s51, v250
    v_cmp_le_u32 vcc, s52, v250
    v_pk_mul_f32 v[32:33], v[32:33], v[248:249] op_sel_hi:[1,0]
    v_pk_mul_f32 v[34:35], v[34:35], v[248:249] op_sel_hi:[1,0]
    v_pk_mul_f32 v[36:37], v[36:37], v[248:249] op_sel_hi:[1,0]
    v_pk_mul_f32 v[38:39], v[38:39], v[248:249] op_sel_hi:[1,0]
    v_pk_mul_f32 v[40:41], v[40:41], v[248:249] op_sel_hi:[1,0]
    v_pk_mul_f32 v[42:43], v[42:43], v[248:249] op_sel_hi:[1,0]
    v_pk_mul_f32 v[44:45], v[44:45], v[248:249] op_sel_hi:[1,0]
    v_pk_mul_f32 v[46:47], v[46:47], v[248:249] op_sel_hi:[1,0]
    s_add_u32 s44, s44, 4096
    buffer_store_dwordx4 v[4:7], v223, s[24:27], s44 offen sc1
    v_pk_mul_f32 v[48:49], v[48:49], v[248:249] op_sel_hi:[1,0]
    v_pk_mul_f32 v[50:51], v[50:51], v[248:249] op_sel_hi:[1,0]
    v_pk_mul_f32 v[52:53], v[52:53], v[248:249] op_sel_hi:[1,0]
    v_pk_mul_f32 v[54:55], v[54:55], v[248:249] op_sel_hi:[1,0]
    v_pk_mul_f32 v[56:57], v[56:57], v[248:249] op_sel_hi:[1,0]
    v_pk_mul_f32 v[58:59], v[58:59], v[248:249] op_sel_hi:[1,0]
    v_pk_mul_f32 v[60:61], v[60:61], v[248:249] op_sel_hi:[1,0]
    v_pk_mul_f32 v[62:63], v[62:63], v[248:249] op_sel_hi:[1,0]
    v_cvt_pk_bf16_f32 v184, v32, v36
    v_cvt_pk_bf16_f32 v185, v40, v44
    v_cvt_pk_bf16_f32 v186, v48, v52
    v_cvt_pk_bf16_f32 v187, v56, v60
    v_cvt_pk_bf16_f32 v188, v33, v37
    s_add_u32 s44, s44, 4096
    buffer_store_dwordx4 v[8:11], v223, s[24:27], s44 offen sc1
    v_cvt_pk_bf16_f32 v189, v41, v45
    v_cvt_pk_bf16_f32 v190, v49, v53
    v_cvt_pk_bf16_f32 v191, v57, v61
    v_mfma_f32_16x16x32_bf16 v[152:155], v[184:187], a[64:67], 0
    s_or_b64 s[48:49], s[48:49], vcc
    v_cvt_pk_bf16_f32 v192, v34, v38
    v_cvt_pk_bf16_f32 v193, v42, v46
    v_mfma_f32_16x16x32_bf16 v[168:171], v[184:187], a[68:71], 0
    v_cvt_pk_bf16_f32 v194, v50, v54
    v_cvt_pk_bf16_f32 v195, v58, v62
    v_mfma_f32_16x16x32_bf16 v[156:159], v[188:191], a[64:67], 0
    v_cvt_pk_bf16_f32 v196, v35, v39
    v_cvt_pk_bf16_f32 v197, v43, v47
    s_add_u32 s44, s44, 4096
    buffer_store_dwordx4 v[12:15], v223, s[24:27], s44 offen sc1
    v_mfma_f32_16x16x32_bf16 v[172:175], v[188:191], a[68:71], 0
    v_cvt_pk_bf16_f32 v198, v51, v55
    v_cvt_pk_bf16_f32 v199, v59, v63
    v_mfma_f32_16x16x32_bf16 v[160:163], v[192:195], a[64:67], 0
    s_nop 0
    v_mfma_f32_16x16x32_bf16 v[176:179], v[192:195], a[68:71], 0
    s_nop 0
    v_mfma_f32_16x16x32_bf16 v[164:167], v[196:199], a[64:67], 0
    v_cvt_pk_bf16_f32 v32, v152, v156
    v_cvt_pk_bf16_f32 v36, v153, v157
    v_mfma_f32_16x16x32_bf16 v[180:183], v[196:199], a[68:71], 0
    v_cvt_pk_bf16_f32 v40, v154, v158
    v_cvt_pk_bf16_f32 v44, v155, v159
    s_add_u32 s44, s44, 53248
    v_mfma_f32_16x16x32_bf16 a[96:99], a[104:107], v[104:107], a[96:99]
    v_cvt_pk_bf16_f32 v34, v168, v172
    v_cvt_pk_bf16_f32 v38, v169, v173
    v_mfma_f32_16x16x32_bf16 v[64:67], a[32:35], v[104:107], v[64:67]
    v_cvt_pk_bf16_f32 v42, v170, v174
    v_cvt_pk_bf16_f32 v46, v171, v175
    v_mfma_f32_16x16x32_bf16 v[68:71], a[36:39], v[104:107], v[68:71]
    v_cvt_pk_bf16_f32 v33, v160, v164
    v_cvt_pk_bf16_f32 v37, v161, v165
    v_mfma_f32_16x16x32_bf16 v[72:75], a[40:43], v[104:107], v[72:75]
    v_cvt_pk_bf16_f32 v35, v176, v180
    v_cvt_pk_bf16_f32 v41, v162, v166
    v_mfma_f32_16x16x32_bf16 v[76:79], a[44:47], v[104:107], v[76:79]
    buffer_store_dwordx4 v[32:35], v223, s[24:27], s44 offen sc1
    v_cvt_pk_bf16_f32 v39, v177, v181
    v_mfma_f32_16x16x32_bf16 v[80:83], a[48:51], v[104:107], v[80:83]
    s_add_u32 s44, s44, 4096
    v_cvt_pk_bf16_f32 v45, v163, v167
    v_cvt_pk_bf16_f32 v43, v178, v182
    v_mfma_f32_16x16x32_bf16 v[84:87], a[52:55], v[104:107], v[84:87]
    v_cvt_pk_bf16_f32 v47, v179, v183
    v_accvgpr_read_b32 v250, a96
    v_mfma_f32_16x16x32_bf16 v[88:91], a[56:59], v[104:107], v[88:91]
    v_rcp_f32 v248, v250
    v_mfma_f32_16x16x32_bf16 v[92:95], a[60:63], v[104:107], v[92:95]
    v_subrev_u32 v250, s51, v250
    v_cmp_le_u32 vcc, s52, v250
    v_pk_mul_f32 v[64:65], v[64:65], v[248:249] op_sel_hi:[1,0]
    v_pk_mul_f32 v[66:67], v[66:67], v[248:249] op_sel_hi:[1,0]
    v_pk_mul_f32 v[68:69], v[68:69], v[248:249] op_sel_hi:[1,0]
    v_pk_mul_f32 v[70:71], v[70:71], v[248:249] op_sel_hi:[1,0]
    v_pk_mul_f32 v[72:73], v[72:73], v[248:249] op_sel_hi:[1,0]
    v_pk_mul_f32 v[74:75], v[74:75], v[248:249] op_sel_hi:[1,0]
    buffer_store_dwordx4 v[36:39], v223, s[24:27], s44 offen sc1
    v_pk_mul_f32 v[76:77], v[76:77], v[248:249] op_sel_hi:[1,0]
    v_pk_mul_f32 v[78:79], v[78:79], v[248:249] op_sel_hi:[1,0]
    v_pk_mul_f32 v[80:81], v[80:81], v[248:249] op_sel_hi:[1,0]
    v_pk_mul_f32 v[82:83], v[82:83], v[248:249] op_sel_hi:[1,0]
    v_pk_mul_f32 v[84:85], v[84:85], v[248:249] op_sel_hi:[1,0]
    v_pk_mul_f32 v[86:87], v[86:87], v[248:249] op_sel_hi:[1,0]
    v_pk_mul_f32 v[88:89], v[88:89], v[248:249] op_sel_hi:[1,0]
    v_pk_mul_f32 v[90:91], v[90:91], v[248:249] op_sel_hi:[1,0]
    v_pk_mul_f32 v[92:93], v[92:93], v[248:249] op_sel_hi:[1,0]
    v_pk_mul_f32 v[94:95], v[94:95], v[248:249] op_sel_hi:[1,0]
    v_cvt_pk_bf16_f32 v184, v64, v68
    v_cvt_pk_bf16_f32 v185, v72, v76
    v_cvt_pk_bf16_f32 v186, v80, v84
    s_add_u32 s44, s44, 4096
    buffer_store_dwordx4 v[40:43], v223, s[24:27], s44 offen sc1
    v_cvt_pk_bf16_f32 v187, v88, v92
    v_cvt_pk_bf16_f32 v188, v65, v69
    v_cvt_pk_bf16_f32 v189, v73, v77
    v_cvt_pk_bf16_f32 v190, v81, v85
    v_cvt_pk_bf16_f32 v191, v89, v93
    v_mfma_f32_16x16x32_bf16 v[152:155], v[184:187], a[64:67], 0
    s_or_b64 s[48:49], s[48:49], vcc
    v_cvt_pk_bf16_f32 v192, v66, v70
    v_cvt_pk_bf16_f32 v193, v74, v78
    v_mfma_f32_16x16x32_bf16 v[168:171], v[184:187], a[68:71], 0
    v_cvt_pk_bf16_f32 v194, v82, v86
    v_cvt_pk_bf16_f32 v195, v90, v94
    v_mfma_f32_16x16x32_bf16 v[156:159], v[188:191], a[64:67], 0
    v_cvt_pk_bf16_f32 v196, v67, v71
    s_add_u32 s44, s44, 4096
    buffer_store_dwordx4 v[44:47], v223, s[24:27], s44 offen sc1
    v_cvt_pk_bf16_f32 v197, v75, v79
    v_mfma_f32_16x16x32_bf16 v[172:175], v[188:191], a[68:71], 0
    v_cvt_pk_bf16_f32 v198, v83, v87
    v_cvt_pk_bf16_f32 v199, v91, v95
    v_mfma_f32_16x16x32_bf16 v[160:163], v[192:195], a[64:67], 0
    s_nop 0
    v_mfma_f32_16x16x32_bf16 v[176:179], v[192:195], a[68:71], 0
    s_nop 0
    v_mfma_f32_16x16x32_bf16 v[164:167], v[196:199], a[64:67], 0
    v_cvt_pk_bf16_f32 v64, v152, v156
    v_cvt_pk_bf16_f32 v68, v153, v157
    v_mfma_f32_16x16x32_bf16 v[180:183], v[196:199], a[68:71], 0
    v_cvt_pk_bf16_f32 v72, v154, v158
    v_cvt_pk_bf16_f32 v76, v155, v159
    s_add_u32 s44, s44, 53248
    v_cvt_pk_bf16_f32 v66, v168, v172
    v_cvt_pk_bf16_f32 v70, v169, v173
    v_cvt_pk_bf16_f32 v74, v170, v174
    v_cvt_pk_bf16_f32 v78, v171, v175
    v_cvt_pk_bf16_f32 v65, v160, v164
    v_cvt_pk_bf16_f32 v69, v161, v165
    v_cvt_pk_bf16_f32 v67, v176, v180
    v_cvt_pk_bf16_f32 v73, v162, v166
    buffer_store_dwordx4 v[64:67], v223, s[24:27], s44 offen sc1
    v_cvt_pk_bf16_f32 v71, v177, v181
    v_cvt_pk_bf16_f32 v77, v163, v167
    s_add_u32 s44, s44, 4096
    buffer_store_dwordx4 v[68:71], v223, s[24:27], s44 offen sc1
    v_cvt_pk_bf16_f32 v75, v178, v182
    s_add_u32 s44, s44, 4096
    buffer_store_dwordx4 v[72:75], v223, s[24:27], s44 offen sc1
    v_cvt_pk_bf16_f32 v79, v179, v183
    s_add_u32 s44, s44, 4096
    buffer_store_dwordx4 v[76:79], v223, s[24:27], s44 offen sc1
    s_cmp_lg_u64 s[48:49], 0
    s_cselect_b32 s57, s41, 0
    s_or_b32 s40, s40, s57
    s_cbranch_scc1 L_slow
    s_endpgm
L_done:
    s_cmp_lg_u32 s40, 0
    s_cbranch_scc1 L_slow
L_end:
    s_endpgm
.p2align 12
L_ch2:
    v_cmp_eq_u32 s[54:55], 3, v247
    v_cmp_eq_u32 s[56:57], 4, v247
    v_cmp_eq_u32 s[58:59], 5, v247
    v_cndmask_b32 v240, 0, v246, s[54:55]
    v_cndmask_b32 v241, 0, v246, s[56:57]
    v_cndmask_b32 v242, 0, v246, s[58:59]
    v_accvgpr_write_b32 a67, v240
    v_accvgpr_write_b32 a68, v241
    v_accvgpr_write_b32 a69, v242
    s_branch L_dfr
L_trans3:
    v_mfma_f32_16x16x32_bf16 v[64:67], a[32:35], v[104:107], v[64:67]
    s_mov_b32 s50, s83
    buffer_load_dwordx4 v216, s[12:15], s35 offen offset:0 nt lds
    v_add_u32 v228, s42, v200
    v_mfma_f32_16x16x32_bf16 v[68:71], a[36:39], v[104:107], v[68:71]
    s_add_u32 m0, s58, 40960
    ds_read_b128 v[152:155], v217 offset:0
    v_add_u32 v229, s42, v201
    v_mfma_f32_16x16x32_bf16 v[72:75], a[40:43], v[104:107], v[72:75]
    s_mov_b32 s53, s87
    buffer_load_dwordx4 v212, s[20:23], s31 offen offset:0  lds
    v_mfma_f32_16x16x32_bf16 v[76:79], a[44:47], v[104:107], v[76:79]
    s_mov_b32 s84, s91
    ds_read_b128 v[156:159], v218 offset:0
    v_add_u32 v230, s42, v202
    v_mfma_f32_16x16x32_bf16 v[80:83], a[48:51], v[104:107], v[80:83]
    s_bfe_u32 s88, s82, 262161
    buffer_load_dwordx4 v213, s[20:23], s31 offen offset:1024  lds
    v_mfma_f32_16x16x32_bf16 v[84:87], a[52:55], v[104:107], v[84:87]
    s_mov_b32 m0, s58
    ds_read_b128 v[160:163], v219 offset:0
    v_add_u32 v231, s42, v203
    v_mfma_f32_16x16x32_bf16 v[88:91], a[56:59], v[104:107], v[88:91]
    s_add_u32 s88, s88, 1
    buffer_load_dwordx4 v214, s[16:19], s32 offen offset:0  lds
    v_mfma_f32_16x16x32_bf16 v[92:95], a[60:63], v[104:107], v[92:95]
    s_bfe_u32 s45, s82, 393237
    ds_read_b128 v[164:167], v220 offset:0
    v_accvgpr_read_b32 v250, a88
    v_mfma_f32_16x16x32_bf16 a[96:99], a[104:107], v[104:107], a[96:99]
    s_bfe_u32 s86, s82, 327683
    buffer_load_dwordx4 v215, s[16:19], s32 offen offset:1024  lds
    v_rcp_f32 v248, v250
    v_subrev_u32 v250, s51, v250
    v_cmp_le_u32 vcc, s52, v250
    v_pk_mul_f32 v[0:1], v[0:1], v[248:249] op_sel_hi:[1,0]
    v_pk_mul_f32 v[2:3], v[2:3], v[248:249] op_sel_hi:[1,0]
    v_pk_mul_f32 v[4:5], v[4:5], v[248:249] op_sel_hi:[1,0]
    v_pk_mul_f32 v[6:7], v[6:7], v[248:249] op_sel_hi:[1,0]
    v_pk_mul_f32 v[8:9], v[8:9], v[248:249] op_sel_hi:[1,0]
    v_pk_mul_f32 v[10:11], v[10:11], v[248:249] op_sel_hi:[1,0]
    v_pk_mul_f32 v[12:13], v[12:13], v[248:249] op_sel_hi:[1,0]
    v_pk_mul_f32 v[14:15], v[14:15], v[248:249] op_sel_hi:[1,0]
    v_pk_mul_f32 v[16:17], v[16:17], v[248:249] op_sel_hi:[1,0]
    v_pk_mul_f32 v[18:19], v[18:19], v[248:249] op_sel_hi:[1,0]
    v_pk_mul_f32 v[20:21], v[20:21], v[248:249] op_sel_hi:[1,0]
    v_pk_mul_f32 v[22:23], v[22:23], v[248:249] op_sel_hi:[1,0]
    v_pk_mul_f32 v[24:25], v[24:25], v[248:249] op_sel_hi:[1,0]
    v_pk_mul_f32 v[26:27], v[26:27], v[248:249] op_sel_hi:[1,0]
    v_pk_mul_f32 v[28:29], v[28:29], v[248:249] op_sel_hi:[1,0]
    v_pk_mul_f32 v[30:31], v[30:31], v[248:249] op_sel_hi:[1,0]
    v_cvt_pk_bf16_f32 v184, v0, v4
    v_cvt_pk_bf16_f32 v185, v8, v12
    v_cvt_pk_bf16_f32 v186, v16, v20
    v_cvt_pk_bf16_f32 v187, v24, v28
    v_cvt_pk_bf16_f32 v188, v1, v5
    v_cvt_pk_bf16_f32 v189, v9, v13
    v_cvt_pk_bf16_f32 v190, v17, v21
    v_cvt_pk_bf16_f32 v191, v25, v29
    v_mfma_f32_16x16x32_bf16 v[128:131], v[184:187], a[64:67], 0
    s_or_b64 s[48:49], s[48:49], vcc
    v_cvt_pk_bf16_f32 v192, v2, v6
    v_cvt_pk_bf16_f32 v193, v10, v14
    v_mfma_f32_16x16x32_bf16 v[144:147], v[184:187], a[68:71], 0
    s_sub_u32 s89, s88, s86
    v_cvt_pk_bf16_f32 v194, v18, v22
    v_cvt_pk_bf16_f32 v195, v26, v30
    v_mfma_f32_16x16x32_bf16 v[132:135], v[188:191], a[64:67], 0
    s_and_b32 s85, s82, 7
    s_cselect_b32 s86, s86, 0
    v_cvt_pk_bf16_f32 v196, v3, v7
    v_cvt_pk_bf16_f32 v197, v11, v15
    v_mfma_f32_16x16x32_bf16 v[148:151], v[188:191], a[68:71], 0
    s_sub_u32 s86, s86, 1
    v_cvt_pk_bf16_f32 v198, v19, v23
    v_cvt_pk_bf16_f32 v199, v27, v31
    v_mfma_f32_16x16x32_bf16 v[136:139], v[192:195], a[64:67], 0
    s_sub_u32 s38, s88, 1
    ds_read_b128 v[168:171], v217 offset:4224
    ds_read_b128 v[172:175], v218 offset:4224
    v_mfma_f32_16x16x32_bf16 v[224:227], v[192:195], a[68:71], 0
    s_min_i32 s88, s38, s86
    ds_read_b128 v[176:179], v219 offset:4224
    ds_read_b128 v[180:183], v220 offset:4224
    v_mfma_f32_16x16x32_bf16 v[140:143], v[196:199], a[64:67], 0
    s_max_i32 s88, s88, 0
    v_cvt_pk_bf16_f32 v0, v128, v132
    v_cvt_pk_bf16_f32 v4, v129, v133
    v_mfma_f32_16x16x32_bf16 v[244:247], v[196:199], a[68:71], 0
    s_sub_u32 s38, s38, s88
    v_cvt_pk_bf16_f32 v8, v130, v134
    v_cvt_pk_bf16_f32 v12, v131, v135
    v_cvt_pk_bf16_f32 v2, v144, v148
    v_cvt_pk_bf16_f32 v6, v145, v149
    v_cvt_pk_bf16_f32 v10, v146, v150
    v_cvt_pk_bf16_f32 v14, v147, v151
    v_cvt_pk_bf16_f32 v1, v136, v140
    v_cvt_pk_bf16_f32 v5, v137, v141
    v_cvt_pk_bf16_f32 v9, v138, v142
    v_cvt_pk_bf16_f32 v13, v139, v143
    v_cvt_pk_bf16_f32 v3, v224, v244
    v_cvt_pk_bf16_f32 v7, v225, v245
    v_cvt_pk_bf16_f32 v11, v226, v246
    v_cvt_pk_bf16_f32 v15, v227, v247
    s_waitcnt lgkmcnt(4)
    buffer_store_dwordx4 v[0:3], v223, s[24:27], s44 offen sc1
    v_lshlrev_b32 v240, 16, v152
    v_and_b32 v241, 0xffff0000, v152
    v_pk_mul_f32 v[240:241], v[240:241], s[46:47]
    v_cvt_pk_bf16_f32 v152, v240, v241
    v_lshlrev_b32 v242, 16, v153
    v_and_b32 v243, 0xffff0000, v153
    v_pk_mul_f32 v[242:243], v[242:243], s[46:47]
    v_cvt_pk_bf16_f32 v153, v242, v243
    v_lshlrev_b32 v240, 16, v154
    v_and_b32 v241, 0xffff0000, v154
    v_pk_mul_f32 v[240:241], v[240:241], s[46:47]
    v_cvt_pk_bf16_f32 v154, v240, v241
    v_lshlrev_b32 v242, 16, v155
    v_and_b32 v243, 0xffff0000, v155
    v_pk_mul_f32 v[242:243], v[242:243], s[46:47]
    v_cvt_pk_bf16_f32 v155, v242, v243
    v_lshlrev_b32 v240, 16, v156
    v_and_b32 v241, 0xffff0000, v156
    v_pk_mul_f32 v[240:241], v[240:241], s[46:47]
    v_cvt_pk_bf16_f32 v156, v240, v241
    v_lshlrev_b32 v242, 16, v157
    v_and_b32 v243, 0xffff0000, v157
    v_pk_mul_f32 v[242:243], v[242:243], s[46:47]
    v_cvt_pk_bf16_f32 v157, v242, v243
    v_lshlrev_b32 v240, 16, v158
    s_add_u32 s44, s44, 4096
    buffer_store_dwordx4 v[4:7], v223, s[24:27], s44 offen sc1
    v_and_b32 v241, 0xffff0000, v158
    v_pk_mul_f32 v[240:241], v[240:241], s[46:47]
    v_cvt_pk_bf16_f32 v158, v240, v241
    v_accvgpr_read_b32 v250, a92
    v_rcp_f32 v248, v250
    v_subrev_u32 v250, s51, v250
    v_cmp_le_u32 vcc, s52, v250
    v_pk_mul_f32 v[32:33], v[32:33], v[248:249] op_sel_hi:[1,0]
    v_pk_mul_f32 v[34:35], v[34:35], v[248:249] op_sel_hi:[1,0]
    v_pk_mul_f32 v[36:37], v[36:37], v[248:249] op_sel_hi:[1,0]
    v_pk_mul_f32 v[38:39], v[38:39], v[248:249] op_sel_hi:[1,0]
    v_pk_mul_f32 v[40:41], v[40:41], v[248:249] op_sel_hi:[1,0]
    v_pk_mul_f32 v[42:43], v[42:43], v[248:249] op_sel_hi:[1,0]
    v_pk_mul_f32 v[44:45], v[44:45], v[248:249] op_sel_hi:[1,0]
    v_pk_mul_f32 v[46:47], v[46:47], v[248:249] op_sel_hi:[1,0]
    v_pk_mul_f32 v[48:49], v[48:49], v[248:249] op_sel_hi:[1,0]
    v_pk_mul_f32 v[50:51], v[50:51], v[248:249] op_sel_hi:[1,0]
    v_pk_mul_f32 v[52:53], v[52:53], v[248:249] op_sel_hi:[1,0]
    v_pk_mul_f32 v[54:55], v[54:55], v[248:249] op_sel_hi:[1,0]
    v_pk_mul_f32 v[56:57], v[56:57], v[248:249] op_sel_hi:[1,0]
    v_pk_mul_f32 v[58:59], v[58:59], v[248:249] op_sel_hi:[1,0]
    v_pk_mul_f32 v[60:61], v[60:61], v[248:249] op_sel_hi:[1,0]
    v_pk_mul_f32 v[62:63], v[62:63], v[248:249] op_sel_hi:[1,0]
    v_cvt_pk_bf16_f32 v184, v32, v36
    v_cvt_pk_bf16_f32 v185, v40, v44
    s_add_u32 s44, s44, 4096
    buffer_store_dwordx4 v[8:11], v223, s[24:27], s44 offen sc1
    v_cvt_pk_bf16_f32 v186, v48, v52
    v_cvt_pk_bf16_f32 v187, v56, v60
    v_cvt_pk_bf16_f32 v188, v33, v37
    v_cvt_pk_bf16_f32 v189, v41, v45
    v_cvt_pk_bf16_f32 v190, v49, v53
    v_cvt_pk_bf16_f32 v191, v57, v61
    v_mfma_f32_16x16x32_bf16 v[128:131], v[184:187], a[64:67], 0
    s_or_b64 s[48:49], s[48:49], vcc
    v_cvt_pk_bf16_f32 v192, v34, v38
    v_cvt_pk_bf16_f32 v193, v42, v46
    v_mfma_f32_16x16x32_bf16 v[144:147], v[184:187], a[68:71], 0
    s_and_b32 s54, s75, 0x1ff00
    v_cvt_pk_bf16_f32 v194, v50, v54
    v_cvt_pk_bf16_f32 v195, v58, v62
    v_mfma_f32_16x16x32_bf16 v[132:135], v[188:191], a[64:67], 0
    s_add_u32 s34, s72, s54
    v_cvt_pk_bf16_f32 v196, v35, v39
    v_cvt_pk_bf16_f32 v197, v43, v47
    v_mfma_f32_16x16x32_bf16 v[148:151], v[188:191], a[68:71], 0
    s_mov_b64 s[80:81], s[72:73]
    v_cvt_pk_bf16_f32 v198, v51, v55
    v_cvt_pk_bf16_f32 v199, v59, v63
    v_mfma_f32_16x16x32_bf16 v[136:139], v[192:195], a[64:67], 0
    s_bfe_u32 s91, s75, 196637
    ds_read_b128 a[0:3], v228 offset:0
    s_add_u32 s44, s44, 4096
    buffer_store_dwordx4 v[12:15], v223, s[24:27], s44 offen sc1
    ds_read_b128 a[4:7], v229 offset:0
    v_mfma_f32_16x16x32_bf16 v[224:227], v[192:195], a[68:71], 0
    s_bfe_u32 s54, s75, 131099
    ds_read_b128 a[8:11], v230 offset:0
    ds_read_b128 a[12:15], v231 offset:0
    v_mfma_f32_16x16x32_bf16 v[140:143], v[196:199], a[64:67], 0
    s_mul_i32 s55, s91, s28
    v_cvt_pk_bf16_f32 v32, v128, v132
    v_cvt_pk_bf16_f32 v36, v129, v133
    v_mfma_f32_16x16x32_bf16 v[244:247], v[196:199], a[68:71], 0
    s_cmp_lt_u32 s28, s54
    s_addc_u32 s91, s91, 0
    v_cvt_pk_bf16_f32 v40, v130, v134
    v_cvt_pk_bf16_f32 v44, v131, v135
    v_cvt_pk_bf16_f32 v34, v144, v148
    v_cvt_pk_bf16_f32 v38, v145, v149
    v_cvt_pk_bf16_f32 v42, v146, v150
    v_cvt_pk_bf16_f32 v46, v147, v151
    v_cvt_pk_bf16_f32 v33, v136, v140
    v_cvt_pk_bf16_f32 v37, v137, v141
    v_cvt_pk_bf16_f32 v41, v138, v142
    v_cvt_pk_bf16_f32 v45, v139, v143
    v_cvt_pk_bf16_f32 v35, v224, v244
    v_cvt_pk_bf16_f32 v39, v225, v245
    v_cvt_pk_bf16_f32 v43, v226, v246
    v_cvt_pk_bf16_f32 v47, v227, v247
    s_add_u32 s44, s44, 53248
    buffer_store_dwordx4 v[32:35], v223, s[24:27], s44 offen sc1
    v_lshlrev_b32 v242, 16, v159
    v_and_b32 v243, 0xffff0000, v159
    v_pk_mul_f32 v[242:243], v[242:243], s[46:47]
    v_cvt_pk_bf16_f32 v159, v242, v243
    v_lshlrev_b32 v240, 16, v160
    v_and_b32 v241, 0xffff0000, v160
    v_pk_mul_f32 v[240:241], v[240:241], s[46:47]
    v_cvt_pk_bf16_f32 v160, v240, v241
    v_lshlrev_b32 v242, 16, v161
    v_and_b32 v243, 0xffff0000, v161
    v_pk_mul_f32 v[242:243], v[242:243], s[46:47]
    v_cvt_pk_bf16_f32 v161, v242, v243
    v_lshlrev_b32 v240, 16, v162
    v_and_b32 v241, 0xffff0000, v162
    v_pk_mul_f32 v[240:241], v[240:241], s[46:47]
    v_cvt_pk_bf16_f32 v162, v240, v241
    v_lshlrev_b32 v242, 16, v163
    v_and_b32 v243, 0xffff0000, v163
    v_pk_mul_f32 v[242:243], v[242:243], s[46:47]
    v_cvt_pk_bf16_f32 v163, v242, v243
    v_lshlrev_b32 v240, 16, v164
    v_and_b32 v241, 0xffff0000, v164
    v_pk_mul_f32 v[240:241], v[240:241], s[46:47]
    v_cvt_pk_bf16_f32 v164, v240, v241
    v_lshlrev_b32 v242, 16, v165
    s_add_u32 s44, s44, 4096
    buffer_store_dwordx4 v[36:39], v223, s[24:27], s44 offen sc1
    v_and_b32 v243, 0xffff0000, v165
    v_pk_mul_f32 v[242:243], v[242:243], s[46:47]
    v_cvt_pk_bf16_f32 v165, v242, v243
    v_accvgpr_read_b32 v250, a96
    v_rcp_f32 v248, v250
    v_subrev_u32 v250, s51, v250
    v_cmp_le_u32 vcc, s52, v250
    v_pk_mul_f32 v[64:65], v[64:65], v[248:249] op_sel_hi:[1,0]
    v_pk_mul_f32 v[66:67], v[66:67], v[248:249] op_sel_hi:[1,0]
    v_pk_mul_f32 v[68:69], v[68:69], v[248:249] op_sel_hi:[1,0]
    v_pk_mul_f32 v[70:71], v[70:71], v[248:249] op_sel_hi:[1,0]
    v_pk_mul_f32 v[72:73], v[72:73], v[248:249] op_sel_hi:[1,0]
    v_pk_mul_f32 v[74:75], v[74:75], v[248:249] op_sel_hi:[1,0]
    v_pk_mul_f32 v[76:77], v[76:77], v[248:249] op_sel_hi:[1,0]
    v_pk_mul_f32 v[78:79], v[78:79], v[248:249] op_sel_hi:[1,0]
    v_pk_mul_f32 v[80:81], v[80:81], v[248:249] op_sel_hi:[1,0]
    v_pk_mul_f32 v[82:83], v[82:83], v[248:249] op_sel_hi:[1,0]
    v_pk_mul_f32 v[84:85], v[84:85], v[248:249] op_sel_hi:[1,0]
    v_pk_mul_f32 v[86:87], v[86:87], v[248:249] op_sel_hi:[1,0]
    v_pk_mul_f32 v[88:89], v[88:89], v[248:249] op_sel_hi:[1,0]
    v_pk_mul_f32 v[90:91], v[90:91], v[248:249] op_sel_hi:[1,0]
    v_pk_mul_f32 v[92:93], v[92:93], v[248:249] op_sel_hi:[1,0]
    v_pk_mul_f32 v[94:95], v[94:95], v[248:249] op_sel_hi:[1,0]
    v_cvt_pk_bf16_f32 v184, v64, v68
    v_cvt_pk_bf16_f32 v185, v72, v76
    s_add_u32 s44, s44, 4096
    buffer_store_dwordx4 v[40:43], v223, s[24:27], s44 offen sc1
    v_cvt_pk_bf16_f32 v186, v80, v84
    v_cvt_pk_bf16_f32 v187, v88, v92
    v_cvt_pk_bf16_f32 v188, v65, v69
    v_cvt_pk_bf16_f32 v189, v73, v77
    v_cvt_pk_bf16_f32 v190, v81, v85
    v_cvt_pk_bf16_f32 v191, v89, v93
    v_mfma_f32_16x16x32_bf16 v[128:131], v[184:187], a[64:67], 0
    s_or_b64 s[48:49], s[48:49], vcc
    v_cvt_pk_bf16_f32 v192, v66, v70
    v_cvt_pk_bf16_f32 v193, v74, v78
    v_mfma_f32_16x16x32_bf16 v[144:147], v[184:187], a[68:71], 0
    s_min_u32 s54, s54, s28
    v_cvt_pk_bf16_f32 v194, v82, v86
    v_cvt_pk_bf16_f32 v195, v90, v94
    v_mfma_f32_16x16x32_bf16 v[132:135], v[188:191], a[64:67], 0
    s_add_u32 s54, s54, s55
    v_cvt_pk_bf16_f32 v196, v67, v71
    v_cvt_pk_bf16_f32 v197, v75, v79
    v_mfma_f32_16x16x32_bf16 v[148:151], v[188:191], a[68:71], 0
    s_lshl_b32 s54, s54, 16
    v_cvt_pk_bf16_f32 v198, v83, v87
    v_cvt_pk_bf16_f32 v199, v91, v95
    v_mfma_f32_16x16x32_bf16 v[136:139], v[192:195], a[64:67], 0
    s_add_u32 s83, s54, s74
    ds_read_b128 a[16:19], v228 offset:1024
    s_add_u32 s44, s44, 4096
    buffer_store_dwordx4 v[44:47], v223, s[24:27], s44 offen sc1
    ds_read_b128 a[20:23], v229 offset:1024
    v_mfma_f32_16x16x32_bf16 v[224:227], v[192:195], a[68:71], 0
    s_lshl_b32 s54, s91, 16
    ds_read_b128 a[24:27], v230 offset:1024
    ds_read_b128 a[28:31], v231 offset:1024
    v_mfma_f32_16x16x32_bf16 v[140:143], v[196:199], a[64:67], 0
    s_add_u32 s54, s54, s83
    v_cvt_pk_bf16_f32 v64, v128, v132
    v_cvt_pk_bf16_f32 v68, v129, v133
    v_mfma_f32_16x16x32_bf16 v[244:247], v[196:199], a[68:71], 0
    s_sub_u32 s54, s54, 3840
    v_cvt_pk_bf16_f32 v72, v130, v134
    v_cvt_pk_bf16_f32 v76, v131, v135
    v_cvt_pk_bf16_f32 v66, v144, v148
    v_cvt_pk_bf16_f32 v70, v145, v149
    v_cvt_pk_bf16_f32 v74, v146, v150
    v_cvt_pk_bf16_f32 v78, v147, v151
    v_cvt_pk_bf16_f32 v65, v136, v140
    v_cvt_pk_bf16_f32 v69, v137, v141
    v_cvt_pk_bf16_f32 v73, v138, v142
    v_cvt_pk_bf16_f32 v77, v139, v143
    v_cvt_pk_bf16_f32 v67, v224, v244
    v_cvt_pk_bf16_f32 v71, v225, v245
    v_cvt_pk_bf16_f32 v75, v226, v246
    v_cvt_pk_bf16_f32 v79, v227, v247
    s_add_u32 s44, s44, 53248
    s_waitcnt lgkmcnt(8)
    buffer_store_dwordx4 v[64:67], v223, s[24:27], s44 offen sc1
    v_lshlrev_b32 v240, 16, v166
    v_and_b32 v241, 0xffff0000, v166
    v_pk_mul_f32 v[240:241], v[240:241], s[46:47]
    v_cvt_pk_bf16_f32 v166, v240, v241
    v_lshlrev_b32 v242, 16, v167
    v_and_b32 v243, 0xffff0000, v167
    v_pk_mul_f32 v[242:243], v[242:243], s[46:47]
    v_cvt_pk_bf16_f32 v167, v242, v243
    v_lshlrev_b32 v240, 16, v168
    v_and_b32 v241, 0xffff0000, v168
    v_pk_mul_f32 v[240:241], v[240:241], s[46:47]
    v_cvt_pk_bf16_f32 v168, v240, v241
    v_lshlrev_b32 v242, 16, v169
    v_and_b32 v243, 0xffff0000, v169
    v_pk_mul_f32 v[242:243], v[242:243], s[46:47]
    v_cvt_pk_bf16_f32 v169, v242, v243
    v_lshlrev_b32 v240, 16, v170
    v_and_b32 v241, 0xffff0000, v170
    v_pk_mul_f32 v[240:241], v[240:241], s[46:47]
    v_cvt_pk_bf16_f32 v170, v240, v241
    v_lshlrev_b32 v242, 16, v171
    v_and_b32 v243, 0xffff0000, v171
    s_add_u32 s44, s44, 4096
    s_min_u32 s87, s54, s34
    buffer_store_dwordx4 v[68:71], v223, s[24:27], s44 offen sc1
    v_pk_mul_f32 v[242:243], v[242:243], s[46:47]
    v_cvt_pk_bf16_f32 v171, v242, v243
    v_lshlrev_b32 v240, 16, v172
    v_and_b32 v241, 0xffff0000, v172
    v_pk_mul_f32 v[240:241], v[240:241], s[46:47]
    v_cvt_pk_bf16_f32 v172, v240, v241
    v_lshlrev_b32 v242, 16, v173
    v_and_b32 v243, 0xffff0000, v173
    v_pk_mul_f32 v[242:243], v[242:243], s[46:47]
    v_cvt_pk_bf16_f32 v173, v242, v243
    v_lshlrev_b32 v240, 16, v174
    v_and_b32 v241, 0xffff0000, v174
    v_pk_mul_f32 v[240:241], v[240:241], s[46:47]
    v_cvt_pk_bf16_f32 v174, v240, v241
    v_lshlrev_b32 v242, 16, v175
    v_and_b32 v243, 0xffff0000, v175
    v_pk_mul_f32 v[242:243], v[242:243], s[46:47]
    v_cvt_pk_bf16_f32 v175, v242, v243
    v_lshlrev_b32 v240, 16, v176
    v_and_b32 v241, 0xffff0000, v176
    v_pk_mul_f32 v[240:241], v[240:241], s[46:47]
    v_cvt_pk_bf16_f32 v176, v240, v241
    v_lshlrev_b32 v242, 16, v177
    s_add_u32 s44, s44, 4096
    s_mov_b32 s14, 0
    buffer_store_dwordx4 v[72:75], v223, s[24:27], s44 offen sc1
    v_and_b32 v243, 0xffff0000, v177
    v_pk_mul_f32 v[242:243], v[242:243], s[46:47]
    v_cvt_pk_bf16_f32 v177, v242, v243
    v_lshlrev_b32 v240, 16, v178
    v_and_b32 v241, 0xffff0000, v178
    v_pk_mul_f32 v[240:241], v[240:241], s[46:47]
    v_cvt_pk_bf16_f32 v178, v240, v241
    v_lshlrev_b32 v242, 16, v179
    v_and_b32 v243, 0xffff0000, v179
    v_pk_mul_f32 v[242:243], v[242:243], s[46:47]
    v_cvt_pk_bf16_f32 v179, v242, v243
    v_lshlrev_b32 v240, 16, v180
    v_and_b32 v241, 0xffff0000, v180
    v_pk_mul_f32 v[240:241], v[240:241], s[46:47]
    v_cvt_pk_bf16_f32 v180, v240, v241
    v_lshlrev_b32 v242, 16, v181
    v_and_b32 v243, 0xffff0000, v181
    v_pk_mul_f32 v[242:243], v[242:243], s[46:47]
    v_cvt_pk_bf16_f32 v181, v242, v243
    v_lshlrev_b32 v240, 16, v182
    v_and_b32 v241, 0xffff0000, v182
    v_pk_mul_f32 v[240:241], v[240:241], s[46:47]
    v_cvt_pk_bf16_f32 v182, v240, v241
    s_add_u32 s44, s44, 4096
    v_mfma_f32_32x32x16_bf16 v[0:15], a[108:111], a[108:111], 0
    s_mov_b32 s36, s37
    buffer_store_dwordx4 v[76:79], v223, s[24:27], s44 offen sc1
    v_lshlrev_b32 v240, 16, v183
    v_and_b32 v241, 0xffff0000, v183
    v_mul_f32 v240, s46, v240
    v_mul_f32 v241, s46, v241
    v_mfma_f32_32x32x16_bf16 v[16:31], a[108:111], a[108:111], 0
    s_mov_b32 s82, s75
    ds_read_b128 v[184:187], v217 offset:8448
    ds_read_b128 v[188:191], v218 offset:8448
    v_cvt_pk_bf16_f32 v183, v240, v241
    v_add_u32 v232, s39, v204
    v_add_u32 v233, s39, v205
    v_add_u32 v234, s39, v206
    v_mfma_f32_32x32x16_bf16 v[48:63], a[108:111], a[108:111], 0
    ds_read_b128 v[192:195], v219 offset:8448
    ds_read_b128 v[196:199], v220 offset:8448
    v_add_u32 v235, s39, v207
    v_add_u32 v236, s39, v208
    v_add_u32 v237, s39, v209
    v_add_u32 v238, s39, v210
    v_mfma_f32_32x32x16_bf16 v[32:47], a[108:111], a[108:111], 0
    v_add_u32 v239, s39, v211
    v_cvt_f32_u32 v244, s45
    v_sub_f32 v244, 0, v244
    v_accvgpr_write_b32 a88, v244
    v_accvgpr_write_b32 a92, v244
    v_accvgpr_write_b32 a96, v244
    s_cmp_eq_u32 s84, 3
    s_cbranch_scc1 L_zero2
L_pro2:
    s_waitcnt lgkmcnt(0)
    s_barrier
    v_mfma_f32_16x16x32_bf16 v[128:131], a[0:3], v[152:155], 0
    s_mov_b32 s31, s32
    ds_read_b64_tr_b16 a[32:33], v232 offset:0
    ds_read_b64_tr_b16 a[34:35], v232 offset:1024
    v_mfma_f32_16x16x32_bf16 v[128:131], a[4:7], v[156:159], v[128:131]
    s_mov_b32 s22, s18
    ds_read_b64_tr_b16 a[36:37], v233 offset:0
    ds_read_b64_tr_b16 a[38:39], v233 offset:1024
    v_mfma_f32_16x16x32_bf16 v[128:131], a[8:11], v[160:163], v[128:131]
    s_sub_u32 s32, s32, 131072
    ds_read_b64_tr_b16 a[40:41], v234 offset:0
    ds_read_b64_tr_b16 a[42:43], v234 offset:1024
    v_mfma_f32_16x16x32_bf16 v[128:131], a[12:15], v[164:167], v[128:131]
    s_cmp_eq_u32 s32, s33
    ds_read_b64_tr_b16 a[44:45], v235 offset:0
    ds_read_b64_tr_b16 a[46:47], v235 offset:1024
    v_mfma_f32_16x16x32_bf16 v[132:135], a[16:19], v[152:155], 0
    s_cselect_b32 s18, s34, s18
    ds_read_b64_tr_b16 a[48:49], v236 offset:0
    ds_read_b64_tr_b16 a[50:51], v236 offset:1024
    v_mfma_f32_16x16x32_bf16 v[132:135], a[20:23], v[156:159], v[132:135]
    s_cselect_b64 s[32:33], s[80:81], s[32:33]
    ds_read_b64_tr_b16 a[52:53], v237 offset:0
    ds_read_b64_tr_b16 a[54:55], v237 offset:1024
    v_mfma_f32_16x16x32_bf16 v[132:135], a[24:27], v[160:163], v[132:135]
    s_cmp_lg_u64 s[48:49], 0
    ds_read_b64_tr_b16 a[56:57], v238 offset:0
    ds_read_b64_tr_b16 a[58:59], v238 offset:1024
    v_mfma_f32_16x16x32_bf16 v[132:135], a[28:31], v[164:167], v[132:135]
    s_cselect_b32 s57, s41, 0
    ds_read_b64_tr_b16 a[60:61], v239 offset:0
    ds_read_b64_tr_b16 a[62:63], v239 offset:1024
    v_mfma_f32_16x16x32_bf16 v[136:139], a[0:3], v[168:171], 0
    s_or_b32 s40, s40, s57
    v_exp_f32 v128, v128
    v_mfma_f32_16x16x32_bf16 v[136:139], a[4:7], v[172:175], v[136:139]
    s_lshl_b32 s41, s41, 1
    v_exp_f32 v129, v129
    v_mfma_f32_16x16x32_bf16 v[136:139], a[8:11], v[176:179], v[136:139]
    s_mov_b64 vcc, 0
    v_exp_f32 v130, v130
    v_mfma_f32_16x16x32_bf16 v[136:139], a[12:15], v[180:183], v[136:139]
    s_mov_b64 s[72:73], 0
    v_exp_f32 v131, v131
    v_mfma_f32_16x16x32_bf16 v[140:143], a[16:19], v[168:171], 0
    s_mov_b64 s[74:75], 0
    v_exp_f32 v132, v132
    v_mfma_f32_16x16x32_bf16 v[140:143], a[20:23], v[172:175], v[140:143]
    s_lshr_b32 s63, s39, 13
    v_exp_f32 v133, v133
    v_mfma_f32_16x16x32_bf16 v[140:143], a[24:27], v[176:179], v[140:143]
    v_exp_f32 v134, v134
    v_mfma_f32_16x16x32_bf16 v[140:143], a[28:31], v[180:183], v[140:143]
    v_exp_f32 v135, v135
    v_cvt_pk_bf16_f32 v144, v128, v129
    v_cvt_pk_bf16_f32 v145, v130, v131
    v_cvt_pk_bf16_f32 v146, v132, v133
    v_cvt_pk_bf16_f32 v147, v134, v135
    s_cmp_eq_u32 s63, 0
    s_cbranch_scc1 L_body2_1
    s_cmp_eq_u32 s63, 1
    s_cbranch_scc1 L_body2_2
    s_cmp_eq_u32 s63, 2
    s_cbranch_scc1 L_body2_3
    s_cmp_eq_u32 s63, 3
    s_cbranch_scc1 L_body2_4
    s_branch L_body2_0
.p2align 7
.type L_table,@object
L_table:
.long 0x00b3d000
.long 0x0095d000
.long 0x0097d000
.long 0x5a1af150
.long 0x00c01100
.long 0x00b81100
.long 0x00ba1100
.long 0x40c59100
.long 0x00000000
.long 0x00000000
.long 0x00000000
.long 0x00000000
.long 0x00000000
.long 0x00000004
.long 0x00000000
.long 0x00000000
.long 0x00b3d200
.long 0x0095d200
.long 0x00a2d200
.long 0x521af150
.long 0x0115a500
.long 0x010da500
.long 0x010fa500
.long 0x41455100
.long 0x00000000
.long 0x00000000
.long 0x00000000
.long 0x00000000
.long 0x00000000
.long 0x00000002
.long 0x00000000
.long 0x00000000
.long 0x00b3d400
.long 0x0095d400
.long 0x0097d400
.long 0x5a1af150
.long 0x00c01500
.long 0x00b81500
.long 0x00ba1500
.long 0x40c59100
.long 0x00000000
.long 0x00000000
.long 0x00000000
.long 0x00000000
.long 0x00000000
.long 0x00000002
.long 0x00000000
.long 0x00000000
.long 0x00b3d600
.long 0x0095d600
.long 0x00a2d600
.long 0x521af150
.long 0x0115a900
.long 0x010da900
.long 0x010fa900
.long 0x41455100
.long 0x00000000
.long 0x00000000
.long 0x00000000
.long 0x00000000
.long 0x00000000
.long 0x00000002
.long 0x00000000
.long 0x00000000
.long 0x00b3d800
.long 0x0095d800
.long 0x0097d800
.long 0x5a1af150
.long 0x00c01900
.long 0x00b81900
.long 0x00ba1900
.long 0x40c59100
.long 0x00000000
.long 0x00000000
.long 0x00000000
.long 0x00000000
.long 0x00000000
.long 0x00000002
.long 0x00000000
.long 0x00000000
.long 0x00b3da00
.long 0x0095da00
.long 0x00a2da00
.long 0x521af150
.long 0x0115ad00
.long 0x010dad00
.long 0x010fad00
.long 0x41455100
.long 0x00000000
.long 0x00000000
.long 0x00000000
.long 0x00000000
.long 0x00000000
.long 0x00000002
.long 0x00000000
.long 0x00000000
.long 0x00b3dc00
.long 0x0095dc00
.long 0x0097dc00
.long 0x5a1af150
.long 0x00c01d00
.long 0x00b81d00
.long 0x00ba1d00
.long 0x40c59100
.long 0x00000000
.long 0x00000000
.long 0x00000000
.long 0x00000000
.long 0x00000000
.long 0x00000002
.long 0x00000000
.long 0x00000000
.long 0x00b3de00
.long 0x0095de00
.long 0x00a2de00
.long 0x521af150
.long 0x0115a100
.long 0x010da100
.long 0x010fa100
.long 0x41455100
.long 0x00000000
.long 0x00000000
.long 0x00000000
.long 0x00000000
.long 0x00000000
.long 0x00000002
.long 0x00000000
.long 0x00000000
.long 0x00b3d100
.long 0x0095d100
.long 0x0097d100
.long 0x5a1af150
.long 0x00b8d300
.long 0x00b2d300
.long 0x00b4d300
.long 0x41833100
.long 0x00000000
.long 0x00000000
.long 0x00000000
.long 0x00000000
.long 0x00000000
.long 0x00000002
.long 0x00000000
.long 0x00000000
.long 0x00b3d300
.long 0x0095d300
.long 0x00a2d300
.long 0x521af150
.long 0x00e69200
.long 0x00de9200
.long 0x00e09200
.long 0x43a42100
.long 0x00000000
.long 0x00000000
.long 0x00000000
.long 0x00000000
.long 0x00000000
.long 0x00000001
.long 0x00000000
.long 0x00000000
.long 0x00b3d500
.long 0x0095d500
.long 0x0097d500
.long 0x5a1af150
.long 0x00b8d700
.long 0x00b2d700
.long 0x00b4d700
.long 0x41833100
.long 0x00000000
.long 0x00000000
.long 0x00000000
.long 0x00000000
.long 0x00000000
.long 0x00000000
.long 0x00000000
.long 0x00000000
.long 0x00b3d700
.long 0x0095d700
.long 0x00a2d700
.long 0x521af150
.long 0x00e69600
.long 0x00de9600
.long 0x00e09600
.long 0x43a42100
.long 0x00000000
.long 0x00000000
.long 0x00000000
.long 0x00000000
.long 0x00000000
.long 0x00000001
.long 0x00000000
.long 0x00000000
.long 0x00b3d900
.long 0x0095d900
.long 0x0097d900
.long 0x5a1af150
.long 0x00b8db00
.long 0x00b2db00
.long 0x00b4db00
.long 0x41833100
.long 0x00000000
.long 0x00000000
.long 0x00000000
.long 0x00000000
.long 0x00000000
.long 0x00000000
.long 0x00000000
.long 0x00000000
.long 0x00b3db00
.long 0x0095db00
.long 0x00a2db00
.long 0x521af150
.long 0x00e69a00
.long 0x00de9a00
.long 0x00e09a00
.long 0x43a42100
.long 0x00000000
.long 0x00000000
.long 0x00000000
.long 0x00000000
.long 0x00000000
.long 0x00000001
.long 0x00000000
.long 0x00000000
.long 0x00b3dd00
.long 0x0095dd00
.long 0x0097dd00
.long 0x5a1af150
.long 0x00b8df00
.long 0x00b2df00
.long 0x00b4df00
.long 0x41833100
.long 0x00000000
.long 0x00000000
.long 0x00000000
.long 0x00000000
.long 0x00000000
.long 0x00000000
.long 0x00000000
.long 0x00000000
.long 0x00b3df00
.long 0x0095df00
.long 0x00a2df00
.long 0x521af150
.long 0x00e69e00
.long 0x00de9e00
.long 0x00e09e00
.long 0x43a42100
.long 0x00000000
.long 0x00000000
.long 0x00000000
.long 0x00000000
.long 0x00000000
.long 0x00000001
.long 0x00000000
.long 0x00000000
.long 0x00b3d000
.long 0x0095d000
.long 0x00a2d000
.long 0x521af150
.long 0x00e69100
.long 0x00de9100
.long 0x00e09100
.long 0x43a42100
.long 0x00000000
.long 0x00000000
.long 0x00000000
.long 0x00000000
.long 0x00000000
.long 0x00000002
.long 0x00000000
.long 0x00000000
.long 0x0100c400
.long 0x00e4c400
.long 0x00e6c400
.long 0x60f98150
.long 0x010e5300
.long 0x01005300
.long 0x01025300
.long 0x416b4100
.long 0x00000000
.long 0x00000000
.long 0x00000000
.long 0x00000000
.long 0x00000000
.long 0x00000002
.long 0x00000000
.long 0x00000000
.long 0x00b3d400
.long 0x0095d400
.long 0x00a2d400
.long 0x521af150
.long 0x00e69500
.long 0x00de9500
.long 0x00e09500
.long 0x43a42100
.long 0x00000000
.long 0x00000000
.long 0x00000000
.long 0x00000000
.long 0x00000000
.long 0x00000000
.long 0x00000000
.long 0x00000000
.long 0x0100c800
.long 0x00e4c800
.long 0x00e6c800
.long 0x60f98150
.long 0x010e5700
.long 0x01005700
.long 0x01025700
.long 0x416b4100
.long 0x00000000
.long 0x00000000
.long 0x00000000
.long 0x00000000
.long 0x00000000
.long 0x00000002
.long 0x00000000
.long 0x00000000
.long 0x00b3d800
.long 0x0095d800
.long 0x00a2d800
.long 0x521af150
.long 0x00e69900
.long 0x00de9900
.long 0x00e09900
.long 0x43a42100
.long 0x00000000
.long 0x00000000
.long 0x00000000
.long 0x00000000
.long 0x00000000
.long 0x00000000
.long 0x00000000
.long 0x00000000
.long 0x0100cc00
.long 0x00e4cc00
.long 0x00e6cc00
.long 0x60f98150
.long 0x010e5b00
.long 0x01005b00
.long 0x01025b00
.long 0x416b4100
.long 0x00000000
.long 0x00000000
.long 0x00000000
.long 0x00000000
.long 0x00000000
.long 0x00000002
.long 0x00000000
.long 0x00000000
.long 0x00b3dc00
.long 0x0095dc00
.long 0x00a2dc00
.long 0x521af150
.long 0x00e69d00
.long 0x00de9d00
.long 0x00e09d00
.long 0x43a42100
.long 0x00000000
.long 0x00000000
.long 0x00000000
.long 0x00000000
.long 0x00000000
.long 0x00000000
.long 0x00000000
.long 0x00000000
.long 0x0100c000
.long 0x00e4c000
.long 0x00e6c000
.long 0x60f98150
.long 0x010e5f00
.long 0x01005f00
.long 0x01025f00
.long 0x416b4100
.long 0x00000000
.long 0x00000000
.long 0x00000000
.long 0x00000000
.long 0x00000000
.long 0x00000002
.long 0x00000000
.long 0x00000000
.long 0x00b3d100
.long 0x0095d100
.long 0x00a2d100
.long 0x521af158
.long 0x00c01000
.long 0x00b81000
.long 0x00ba1000
.long 0x40c59100
.long 0x00000000
.long 0x00000000
.long 0x00000000
.long 0x00000000
.long 0x00000000
.long 0x00000003
.long 0x00000000
.long 0x00000000
.long 0x0100c500
.long 0x00e4c500
.long 0x00e6c500
.long 0x60f98150
.long 0x000c0300
.long 0xfffe0300
.long 0x00000300
.long 0x426ac100
.long 0x00000000
.long 0x00000000
.long 0x00000000
.long 0x00000000
.long 0x00000000
.long 0x00000004
.long 0x00000000
.long 0x00000000
.long 0x00b3d500
.long 0x0095d500
.long 0x00a2d500
.long 0x521af158
.long 0x00c01400
.long 0x00b81400
.long 0x00ba1400
.long 0x40c59100
.long 0x00000000
.long 0x00000000
.long 0x00000000
.long 0x00000000
.long 0x00000000
.long 0x00000001
.long 0x00000000
.long 0x00000000
.long 0x0100c900
.long 0x00e4c900
.long 0x00e6c900
.long 0x60f98150
.long 0x000c0700
.long 0xfffe0700
.long 0x00000700
.long 0x426ac100
.long 0x00000000
.long 0x00000000
.long 0x00000000
.long 0x00000000
.long 0x00000000
.long 0x00000004
.long 0x00000000
.long 0x00000000
.long 0x00b3d900
.long 0x0095d900
.long 0x00a2d900
.long 0x521af158
.long 0x00c01800
.long 0x00b81800
.long 0x00ba1800
.long 0x40c59100
.long 0x00000000
.long 0x00000000
.long 0x00000000
.long 0x00000000
.long 0x00000000
.long 0x00000001
.long 0x00000000
.long 0x00000000
.long 0x0100cd00
.long 0x00e4cd00
.long 0x00e6cd00
.long 0x60f98150
.long 0x000c0b00
.long 0xfffe0b00
.long 0x00000b00
.long 0x426ac100
.long 0x00000000
.long 0x00000000
.long 0x00000000
.long 0x00000000
.long 0x00000000
.long 0x00000004
.long 0x00000000
.long 0x00000000
.long 0x00b3dd00
.long 0x0095dd00
.long 0x00a2dd00
.long 0x521af158
.long 0x00c01c00
.long 0x00b81c00
.long 0x00ba1c00
.long 0x40c59100
.long 0x00000000
.long 0x00000000
.long 0x00000000
.long 0x00000000
.long 0x00000000
.long 0x00000001
.long 0x00000000
.long 0x00000000
.long 0x0100c100
.long 0x00e4c100
.long 0x00e6c100
.long 0x60f98150
.long 0x000c0f00
.long 0xfffe0f00
.long 0x00000f00
.long 0x426ac100
.long 0x00000000
.long 0x00000000
.long 0x00000000
.long 0x00000000
.long 0x00000000
.long 0x00000004
.long 0x00000000
.long 0x00000000
.long 0x0100c200
.long 0x00e4c200
.long 0x00f2c200
.long 0x40f98170
.long 0x004aa300
.long 0x0036a300
.long 0x0038a300
.long 0x61f10100
.long 0x00000000
.long 0x00000000
.long 0x00000000
.long 0x00000000
.long 0x00000000
.long 0x00000004
.long 0x00000000
.long 0x00000000
.long 0x0100c400
.long 0x00e4c400
.long 0x00f2c400
.long 0x40f98170
.long 0x00962400
.long 0x00822400
.long 0x00842400
.long 0x60b1a100
.long 0x00000000
.long 0x00000000
.long 0x00000000
.long 0x00000000
.long 0x00000000
.long 0x00000004
.long 0x00000000
.long 0x00000000
.long 0x0100c600
.long 0x00e4c600
.long 0x00f2c600
.long 0x40f98170
.long 0x004aa700
.long 0x0036a700
.long 0x0038a700
.long 0x61f10100
.long 0x00000000
.long 0x00000000
.long 0x00000000
.long 0x00000000
.long 0x00000000
.long 0x00000002
.long 0x00000000
.long 0x00000000
.long 0x0100c800
.long 0x00e4c800
.long 0x00f2c800
.long 0x40f98170
.long 0x00962800
.long 0x00822800
.long 0x00842800
.long 0x60b1a100
.long 0x00000000
.long 0x00000000
.long 0x00000000
.long 0x00000000
.long 0x00000000
.long 0x00000004
.long 0x00000000
.long 0x00000000
.long 0x0100ca00
.long 0x00e4ca00
.long 0x00f2ca00
.long 0x40f98170
.long 0x004aab00
.long 0x0036ab00
.long 0x0038ab00
.long 0x61f10100
.long 0x00000000
.long 0x00000000
.long 0x00000000
.long 0x00000000
.long 0x00000000
.long 0x00000002
.long 0x00000000
.long 0x00000000
.long 0x0100cc00
.long 0x00e4cc00
.long 0x00f2cc00
.long 0x40f98170
.long 0x00962c00
.long 0x00822c00
.long 0x00842c00
.long 0x60b1a100
.long 0x00000000
.long 0x00000000
.long 0x00000000
.long 0x00000000
.long 0x00000000
.long 0x00000004
.long 0x00000000
.long 0x00000000
.long 0x0100ce00
.long 0x00e4ce00
.long 0x00f2ce00
.long 0x40f98170
.long 0x004aaf00
.long 0x0036af00
.long 0x0038af00
.long 0x61f10100
.long 0x00000000
.long 0x00000000
.long 0x00000000
.long 0x00000000
.long 0x00000000
.long 0x00000002
.long 0x00000000
.long 0x00000000
.long 0x0100c000
.long 0x00e4c000
.long 0x00f2c000
.long 0x40f98170
.long 0x00962000
.long 0x00822000
.long 0x00842000
.long 0x60b1a100
.long 0x00000000
.long 0x00000000
.long 0x00000000
.long 0x00000000
.long 0x00000000
.long 0x00000004
.long 0x00000000
.long 0x00000000
.long 0x00388000
.long 0x001e8000
.long 0x00298000
.long 0x43d61168
.long 0x001ed300
.long 0x000ad300
.long 0x000cd300
.long 0x60b1a100
.long 0x00000000
.long 0x00000000
.long 0x00000000
.long 0x00000000
.long 0x00000000
.long 0x00000004
.long 0x00000000
.long 0x00000000
.long 0x0100c400
.long 0x00e4c400
.long 0x00fac400
.long 0x40f98170
.long 0x004aa400
.long 0x0036a400
.long 0x0038a400
.long 0x61f10100
.long 0x00000000
.long 0x00000000
.long 0x00000000
.long 0x00000000
.long 0x00000000
.long 0x00000004
.long 0x00000000
.long 0x00000000
.long 0x00388400
.long 0x001e8400
.long 0x00298400
.long 0x43d61168
.long 0x001ed700
.long 0x000ad700
.long 0x000cd700
.long 0x60b1a100
.long 0x00000000
.long 0x00000000
.long 0x00000000
.long 0x00000000
.long 0x00000000
.long 0x00000002
.long 0x00000000
.long 0x00000000
.long 0x0100c800
.long 0x00e4c800
.long 0x00fac800
.long 0x40f98170
.long 0x004aa800
.long 0x0036a800
.long 0x0038a800
.long 0x61f10100
.long 0x00000000
.long 0x00000000
.long 0x00000000
.long 0x00000000
.long 0x00000000
.long 0x00000004
.long 0x00000000
.long 0x00000000
.long 0x00388800
.long 0x001e8800
.long 0x00298800
.long 0x43d61168
.long 0x001edb00
.long 0x000adb00
.long 0x000cdb00
.long 0x60b1a100
.long 0x00000000
.long 0x00000000
.long 0x00000000
.long 0x00000000
.long 0x00000000
.long 0x00000002
.long 0x00000000
.long 0x00000000
.long 0x0100cc00
.long 0x00e4cc00
.long 0x00facc00
.long 0x40f98170
.long 0x004aac00
.long 0x0036ac00
.long 0x0038ac00
.long 0x61f10100
.long 0x00000000
.long 0x00000000
.long 0x00000000
.long 0x00000000
.long 0x00000000
.long 0x00000004
.long 0x00000000
.long 0x00000000
.long 0x00388c00
.long 0x001e8c00
.long 0x00298c00
.long 0x43d61168
.long 0x001edf00
.long 0x000adf00
.long 0x000cdf00
.long 0x60b1a100
.long 0x00000000
.long 0x00000000
.long 0x00000000
.long 0x00000000
.long 0x00000000
.long 0x00000002
.long 0x00000000
.long 0x00000000
.long 0x0100c000
.long 0x00e4c000
.long 0x00fac000
.long 0x40f98170
.long 0x004aa000
.long 0x0036a000
.long 0x0038a000
.long 0x61f10100
.long 0x00000000
.long 0x00000000
.long 0x00000000
.long 0x00000000
.long 0x00000000
.long 0x00000004
.long 0x00000000
.long 0x00000000
.long 0x0100c200
.long 0x00e4c200
.long 0x00fac200
.long 0x40f98170
.long 0x004aa200
.long 0x0036a200
.long 0x0038a200
.long 0x61f10100
.long 0x00000000
.long 0x00000000
.long 0x00000000
.long 0x00000000
.long 0x00000000
.long 0x00000004
.long 0x00000000
.long 0x00000000
.long 0x00388200
.long 0x001e8200
.long 0x00298200
.long 0x43d61168
.long 0x004aa500
.long 0x0036a500
.long 0x0038a500
.long 0x61f10100
.long 0x00000000
.long 0x00000000
.long 0x00000000
.long 0x00000000
.long 0x00000000
.long 0x00000004
.long 0x00000000
.long 0x00000000
.long 0x0100c600
.long 0x00e4c600
.long 0x00fac600
.long 0x40f98170
.long 0x004aa600
.long 0x0036a600
.long 0x0038a600
.long 0x61f10100
.long 0x00000000
.long 0x00000000
.long 0x00000000
.long 0x00000000
.long 0x00000000
.long 0x00000002
.long 0x00000000
.long 0x00000000
.long 0x00388600
.long 0x001e8600
.long 0x00298600
.long 0x43d61168
.long 0x004aa900
.long 0x0036a900
.long 0x0038a900
.long 0x61f10100
.long 0x00000000
.long 0x00000000
.long 0x00000000
.long 0x00000000
.long 0x00000000
.long 0x00000004
.long 0x00000000
.long 0x00000000
.long 0x0100ca00
.long 0x00e4ca00
.long 0x00faca00
.long 0x40f98170
.long 0x004aaa00
.long 0x0036aa00
.long 0x0038aa00
.long 0x61f10100
.long 0x00000000
.long 0x00000000
.long 0x00000000
.long 0x00000000
.long 0x00000000
.long 0x00000002
.long 0x00000000
.long 0x00000000
.long 0x00388a00
.long 0x001e8a00
.long 0x00298a00
.long 0x43d61168
.long 0x004aad00
.long 0x0036ad00
.long 0x0038ad00
.long 0x61f10100
.long 0x00000000
.long 0x00000000
.long 0x00000000
.long 0x00000000
.long 0x00000000
.long 0x00000004
.long 0x00000000
.long 0x00000000
.long 0x0100ce00
.long 0x00e4ce00
.long 0x00face00
.long 0x40f98170
.long 0x004aae00
.long 0x0036ae00
.long 0x0038ae00
.long 0x61f10100
.long 0x00000000
.long 0x00000000
.long 0x00000000
.long 0x00000000
.long 0x00000000
.long 0x00000002
.long 0x00000000
.long 0x00000000
.long 0x00388e00
.long 0x001e8e00
.long 0x00298e00
.long 0x43d61168
.long 0x004aa100
.long 0x0036a100
.long 0x0038a100
.long 0x61f10100
.long 0x00000000
.long 0x00000000
.long 0x00000000
.long 0x00000000
.long 0x00000000
.long 0x00000004
.long 0x00000000
.long 0x00000000
.long 0x0100c300
.long 0x00e4c300
.long 0x00fac300
.long 0x40f98170
.long 0x00962200
.long 0x00822200
.long 0x00842200
.long 0x60b1a100
.long 0x00000000
.long 0x00000000
.long 0x00000000
.long 0x00000000
.long 0x00000000
.long 0x00000004
.long 0x00000000
.long 0x00000000
.long 0x00388300
.long 0x001e8300
.long 0x00298300
.long 0x43d61168
.long 0x001ed400
.long 0x000ad400
.long 0x000cd400
.long 0x60b1a100
.long 0x00000000
.long 0x00000000
.long 0x00000000
.long 0x00000000
.long 0x00000000
.long 0x00000004
.long 0x00000000
.long 0x00000000
.long 0x0100c700
.long 0x00e4c700
.long 0x00fac700
.long 0x40f98170
.long 0x00962600
.long 0x00822600
.long 0x00842600
.long 0x60b1a100
.long 0x00000000
.long 0x00000000
.long 0x00000000
.long 0x00000000
.long 0x00000000
.long 0x00000004
.long 0x00000000
.long 0x00000000
.long 0x00388700
.long 0x001e8700
.long 0x00298700
.long 0x43d61168
.long 0x001ed800
.long 0x000ad800
.long 0x000cd800
.long 0x60b1a100
.long 0x00000000
.long 0x00000000
.long 0x00000000
.long 0x00000000
.long 0x00000000
.long 0x00000004
.long 0x00000000
.long 0x00000000
.long 0x0100cb00
.long 0x00e4cb00
.long 0x00facb00
.long 0x40f98170
.long 0x00962a00
.long 0x00822a00
.long 0x00842a00
.long 0x60b1a100
.long 0x00000000
.long 0x00000000
.long 0x00000000
.long 0x00000000
.long 0x00000000
.long 0x00000004
.long 0x00000000
.long 0x00000000
.long 0x00388b00
.long 0x001e8b00
.long 0x00298b00
.long 0x43d61168
.long 0x001edc00
.long 0x000adc00
.long 0x000cdc00
.long 0x60b1a100
.long 0x00000000
.long 0x00000000
.long 0x00000000
.long 0x00000000
.long 0x00000000
.long 0x00000004
.long 0x00000000
.long 0x00000000
.long 0x0100cf00
.long 0x00e4cf00
.long 0x00facf00
.long 0x40f98170
.long 0x00962e00
.long 0x00822e00
.long 0x00842e00
.long 0x60b1a100
.long 0x00000000
.long 0x00000000
.long 0x00000000
.long 0x00000000
.long 0x00000000
.long 0x00000004
.long 0x00000000
.long 0x00000000
.long 0x00388f00
.long 0x001e8f00
.long 0x00298f00
.long 0x43d61168
.long 0x001ed000
.long 0x000ad000
.long 0x000cd000
.long 0x60b1a100
.long 0x00000000
.long 0x00000000
.long 0x00000000
.long 0x00000000
.long 0x00000000
.long 0x00000004
.long 0x00000000
.long 0x00000000
.long 0x0100c200
.long 0x00e4c200
.long 0x00e6c200
.long 0x60f98150
.long 0x000c0100
.long 0xfffe0100
.long 0x00000100
.long 0x426ac100
.long 0x00000000
.long 0x00000000
.long 0x00000000
.long 0x00000000
.long 0x00000000
.long 0x00000003
.long 0x00000000
.long 0x00000000
.long 0x00388200
.long 0x001e8200
.long 0x00208200
.long 0x4bd61150
.long 0x00838200
.long 0x00758200
.long 0x00778200
.long 0x42ca9100
.long 0x00000000
.long 0x00000000
.long 0x00000000
.long 0x00000000
.long 0x00000000
.long 0x00000000
.long 0x00000000
.long 0x00000000
.long 0x0100c600
.long 0x00e4c600
.long 0x00e6c600
.long 0x60f98150
.long 0x000c0500
.long 0xfffe0500
.long 0x00000500
.long 0x426ac100
.long 0x00000000
.long 0x00000000
.long 0x00000000
.long 0x00000000
.long 0x00000000
.long 0x00000001
.long 0x00000000
.long 0x00000000
.long 0x00388600
.long 0x001e8600
.long 0x00208600
.long 0x4bd61150
.long 0x00838600
.long 0x00758600
.long 0x00778600
.long 0x42ca9100
.long 0x00000000
.long 0x00000000
.long 0x00000000
.long 0x00000000
.long 0x00000000
.long 0x00000000
.long 0x00000000
.long 0x00000000
.long 0x0100ca00
.long 0x00e4ca00
.long 0x00e6ca00
.long 0x60f98150
.long 0x000c0900
.long 0xfffe0900
.long 0x00000900
.long 0x426ac100
.long 0x00000000
.long 0x00000000
.long 0x00000000
.long 0x00000000
.long 0x00000000
.long 0x00000001
.long 0x00000000
.long 0x00000000
.long 0x00388a00
.long 0x001e8a00
.long 0x00208a00
.long 0x4bd61150
.long 0x00838a00
.long 0x00758a00
.long 0x00778a00
.long 0x42ca9100
.long 0x00000000
.long 0x00000000
.long 0x00000000
.long 0x00000000
.long 0x00000000
.long 0x00000000
.long 0x00000000
.long 0x00000000
.long 0x0100ce00
.long 0x00e4ce00
.long 0x00e6ce00
.long 0x60f98150
.long 0x000c0d00
.long 0xfffe0d00
.long 0x00000d00
.long 0x426ac100
.long 0x00000000
.long 0x00000000
.long 0x00000000
.long 0x00000000
.long 0x00000000
.long 0x00000001
.long 0x00000000
.long 0x00000000
.long 0x00388e00
.long 0x001e8e00
.long 0x00208e00
.long 0x4bd61150
.long 0x00838e00
.long 0x00758e00
.long 0x00778e00
.long 0x42ca9100
.long 0x00000000
.long 0x00000000
.long 0x00000000
.long 0x00000000
.long 0x00000000
.long 0x00000000
.long 0x00000000
.long 0x00000000
.long 0x0100c300
.long 0x00e4c300
.long 0x00e6c300
.long 0x60f98150
.long 0x00838100
.long 0x00758100
.long 0x00778100
.long 0x42ca9100
.long 0x00000000
.long 0x00000000
.long 0x00000000
.long 0x00000000
.long 0x00000000
.long 0x00000003
.long 0x00000000
.long 0x00000000
.long 0x00388300
.long 0x001e8300
.long 0x00208300
.long 0x4bd61150
.long 0x010e5200
.long 0x01005200
.long 0x010a5200
.long 0x416b4100
.long 0x00000000
.long 0x00000000
.long 0x00000000
.long 0x00000000
.long 0x00000000
.long 0x00000001
.long 0x00000000
.long 0x00000000
.long 0x0100c700
.long 0x00e4c700
.long 0x00e6c700
.long 0x60f98150
.long 0x00838500
.long 0x00758500
.long 0x00778500
.long 0x42ca9100
.long 0x00000000
.long 0x00000000
.long 0x00000000
.long 0x00000000
.long 0x00000000
.long 0x00000001
.long 0x00000000
.long 0x00000000
.long 0x00388700
.long 0x001e8700
.long 0x00208700
.long 0x4bd61150
.long 0x010e5600
.long 0x01005600
.long 0x010a5600
.long 0x416b4100
.long 0x00000000
.long 0x00000000
.long 0x00000000
.long 0x00000000
.long 0x00000000
.long 0x00000001
.long 0x00000000
.long 0x00000000
.long 0x0100cb00
.long 0x00e4cb00
.long 0x00e6cb00
.long 0x60f98150
.long 0x00838900
.long 0x00758900
.long 0x00778900
.long 0x42ca9100
.long 0x00000000
.long 0x00000000
.long 0x00000000
.long 0x00000000
.long 0x00000000
.long 0x00000001
.long 0x00000000
.long 0x00000000
.long 0x00388b00
.long 0x001e8b00
.long 0x00208b00
.long 0x4bd61150
.long 0x010e5a00
.long 0x01005a00
.long 0x010a5a00
.long 0x416b4100
.long 0x00000000
.long 0x00000000
.long 0x00000000
.long 0x00000000
.long 0x00000000
.long 0x00000001
.long 0x00000000
.long 0x00000000
.long 0x0100cf00
.long 0x00e4cf00
.long 0x00e6cf00
.long 0x60f98150
.long 0x00838d00
.long 0x00758d00
.long 0x00778d00
.long 0x42ca9100
.long 0x00000000
.long 0x00000000
.long 0x00000000
.long 0x00000000
.long 0x00000000
.long 0x00000001
.long 0x00000000
.long 0x00000000
.long 0x00388f00
.long 0x001e8f00
.long 0x00208f00
.long 0x4bd61150
.long 0x010e5e00
.long 0x01005e00
.long 0x010a5e00
.long 0x416b4100
.long 0x00000000
.long 0x00000000
.long 0x00000000
.long 0x00000000
.long 0x00000000
.long 0x00000001
.long 0x00000000
.long 0x00000000
.long 0x00388000
.long 0x001e8000
.long 0x00208000
.long 0x4bd61150
.long 0x010e5000
.long 0x01005000
.long 0x010a5000
.long 0x416b4100
.long 0x00000000
.long 0x00000000
.long 0x00000000
.long 0x00000000
.long 0x00000000
.long 0x00000002
.long 0x00000000
.long 0x00000000
.long 0x0061b200
.long 0x0049b200
.long 0x004bb200
.long 0x61953150
.long 0x010e5200
.long 0x01005200
.long 0x01025200
.long 0x416b4100
.long 0x00000000
.long 0x00000000
.long 0x00000000
.long 0x00000000
.long 0x00000000
.long 0x00000001
.long 0x00000000
.long 0x00000000
.long 0x00388400
.long 0x001e8400
.long 0x00208400
.long 0x4bd61150
.long 0x010e5400
.long 0x01005400
.long 0x010a5400
.long 0x416b4100
.long 0x00000000
.long 0x00000000
.long 0x00000000
.long 0x00000000
.long 0x00000000
.long 0x00000000
.long 0x00000000
.long 0x00000000
.long 0x0061b600
.long 0x0049b600
.long 0x004bb600
.long 0x61953150
.long 0x010e5600
.long 0x01005600
.long 0x01025600
.long 0x416b4100
.long 0x00000000
.long 0x00000000
.long 0x00000000
.long 0x00000000
.long 0x00000000
.long 0x00000001
.long 0x00000000
.long 0x00000000
.long 0x00388800
.long 0x001e8800
.long 0x00208800
.long 0x4bd61150
.long 0x010e5800
.long 0x01005800
.long 0x010a5800
.long 0x416b4100
.long 0x00000000
.long 0x00000000
.long 0x00000000
.long 0x00000000
.long 0x00000000
.long 0x00000000
.long 0x00000000
.long 0x00000000
.long 0x0061ba00
.long 0x0049ba00
.long 0x004bba00
.long 0x61953150
.long 0x010e5a00
.long 0x01005a00
.long 0x01025a00
.long 0x416b4100
.long 0x00000000
.long 0x00000000
.long 0x00000000
.long 0x00000000
.long 0x00000000
.long 0x00000001
.long 0x00000000
.long 0x00000000
.long 0x00388c00
.long 0x001e8c00
.long 0x00208c00
.long 0x4bd61150
.long 0x010e5c00
.long 0x01005c00
.long 0x010a5c00
.long 0x416b4100
.long 0x00000000
.long 0x00000000
.long 0x00000000
.long 0x00000000
.long 0x00000000
.long 0x00000000
.long 0x00000000
.long 0x00000000
.long 0x0061be00
.long 0x0049be00
.long 0x004bbe00
.long 0x61953150
.long 0x010e5e00
.long 0x01005e00
.long 0x01025e00
.long 0x416b4100
.long 0x00000000
.long 0x00000000
.long 0x00000000
.long 0x00000000
.long 0x00000000
.long 0x00000001
.long 0x00000000
.long 0x00000000
.long 0x00388100
.long 0x001e8100
.long 0x00208100
.long 0x4bd61150
.long 0x010e5000
.long 0x01005000
.long 0x01025000
.long 0x416b4100
.long 0x00000000
.long 0x00000000
.long 0x00000000
.long 0x00000000
.long 0x00000000
.long 0x00000002
.long 0x00000000
.long 0x00000000
.long 0x0061b300
.long 0x0049b300
.long 0x004bb300
.long 0x61953150
.long 0x00838200
.long 0x00758200
.long 0x007f8200
.long 0x42ca9100
.long 0x00000000
.long 0x00000000
.long 0x00000000
.long 0x00000000
.long 0x00000000
.long 0x00000002
.long 0x00000000
.long 0x00000000
.long 0x00388500
.long 0x001e8500
.long 0x00208500
.long 0x4bd61150
.long 0x010e5400
.long 0x01005400
.long 0x01025400
.long 0x416b4100
.long 0x00000000
.long 0x00000000
.long 0x00000000
.long 0x00000000
.long 0x00000000
.long 0x00000000
.long 0x00000000
.long 0x00000000
.long 0x0061b700
.long 0x0049b700
.long 0x004bb700
.long 0x61953150
.long 0x00838600
.long 0x00758600
.long 0x007f8600
.long 0x42ca9100
.long 0x00000000
.long 0x00000000
.long 0x00000000
.long 0x00000000
.long 0x00000000
.long 0x00000002
.long 0x00000000
.long 0x00000000
.long 0x00388900
.long 0x001e8900
.long 0x00208900
.long 0x4bd61150
.long 0x010e5800
.long 0x01005800
.long 0x01025800
.long 0x416b4100
.long 0x00000000
.long 0x00000000
.long 0x00000000
.long 0x00000000
.long 0x00000000
.long 0x00000000
.long 0x00000000
.long 0x00000000
.long 0x0061bb00
.long 0x0049bb00
.long 0x004bbb00
.long 0x61953150
.long 0x00838a00
.long 0x00758a00
.long 0x007f8a00
.long 0x42ca9100
.long 0x00000000
.long 0x00000000
.long 0x00000000
.long 0x00000000
.long 0x00000000
.long 0x00000002
.long 0x00000000
.long 0x00000000
.long 0x00388d00
.long 0x001e8d00
.long 0x00208d00
.long 0x4bd61150
.long 0x010e5c00
.long 0x01005c00
.long 0x01025c00
.long 0x416b4100
.long 0x00000000
.long 0x00000000
.long 0x00000000
.long 0x00000000
.long 0x00000000
.long 0x00000000
.long 0x00000000
.long 0x00000000
.long 0x0061bf00
.long 0x0049bf00
.long 0x004bbf00
.long 0x61953150
.long 0x00838e00
.long 0x00758e00
.long 0x007f8e00
.long 0x42ca9100
.long 0x00000000
.long 0x00000000
.long 0x00000000
.long 0x00000000
.long 0x00000000
.long 0x00000002
.long 0x00000000
.long 0x00000000
.long 0x00b3d000
.long 0x0095d000
.long 0x00acd000
.long 0x421af150
.long 0x00962300
.long 0x00822300
.long 0x00902300
.long 0x40b1a100
.long 0x00000000
.long 0x00000000
.long 0x00000000
.long 0x00000000
.long 0x00000000
.long 0x00000002
.long 0x00000000
.long 0x00000000
.long 0x0100c500
.long 0x00e4c500
.long 0x00fac500
.long 0x40f98150
.long 0x000c0300
.long 0xfffe0300
.long 0x00080300
.long 0x426ac100
.long 0x00000000
.long 0x00000000
.long 0x00000000
.long 0x00000000
.long 0x00000000
.long 0x00000000
.long 0x00000000
.long 0x00000000
.long 0x00b3d400
.long 0x0095d400
.long 0x00acd400
.long 0x421af150
.long 0x00962700
.long 0x00822700
.long 0x00902700
.long 0x40b1a100
.long 0x00000000
.long 0x00000000
.long 0x00000000
.long 0x00000000
.long 0x00000000
.long 0x00000000
.long 0x00000000
.long 0x00000000
.long 0x0100c900
.long 0x00e4c900
.long 0x00fac900
.long 0x40f98150
.long 0x000c0700
.long 0xfffe0700
.long 0x00080700
.long 0x426ac100
.long 0x00000000
.long 0x00000000
.long 0x00000000
.long 0x00000000
.long 0x00000000
.long 0x00000000
.long 0x00000000
.long 0x00000000
.long 0x00b3d800
.long 0x0095d800
.long 0x00acd800
.long 0x421af150
.long 0x00962b00
.long 0x00822b00
.long 0x00902b00
.long 0x40b1a100
.long 0x00000000
.long 0x00000000
.long 0x00000000
.long 0x00000000
.long 0x00000000
.long 0x00000000
.long 0x00000000
.long 0x00000000
.long 0x0100cd00
.long 0x00e4cd00
.long 0x00facd00
.long 0x40f98150
.long 0x000c0b00
.long 0xfffe0b00
.long 0x00080b00
.long 0x426ac100
.long 0x00000000
.long 0x00000000
.long 0x00000000
.long 0x00000000
.long 0x00000000
.long 0x00000000
.long 0x00000000
.long 0x00000000
.long 0x00b3dc00
.long 0x0095dc00
.long 0x00acdc00
.long 0x421af150
.long 0x00962f00
.long 0x00822f00
.long 0x00902f00
.long 0x40b1a100
.long 0x00000000
.long 0x00000000
.long 0x00000000
.long 0x00000000
.long 0x00000000
.long 0x00000000
.long 0x00000000
.long 0x00000000
.long 0x0100c100
.long 0x00e4c100
.long 0x00fac100
.long 0x40f98150
.long 0x000c0f00
.long 0xfffe0f00
.long 0x00080f00
.long 0x426ac100
.long 0x00000000
.long 0x00000000
.long 0x00000000
.long 0x00000000
.long 0x00000000
.long 0x00000000
.long 0x00000000
.long 0x00000000
.long 0x00b3d100
.long 0x0095d100
.long 0x00acd100
.long 0x421af158
.long 0x00838000
.long 0x00758000
.long 0x007f8000
.long 0x42ca9100
.long 0x00000000
.long 0x00000000
.long 0x00000000
.long 0x00000000
.long 0x00000000
.long 0x00000002
.long 0x00000000
.long 0x00000000
.long 0x00388200
.long 0x001e8200
.long 0x00318200
.long 0x43d61150
.long 0x0100c500
.long 0x00e4c500
.long 0x00f2c500
.long 0x40f98100
.long 0x00000000
.long 0x00000000
.long 0x00000000
.long 0x00000000
.long 0x00000000
.long 0x00000002
.long 0x00000000
.long 0x00000000
.long 0x00b3d500
.long 0x0095d500
.long 0x00acd500
.long 0x421af158
.long 0x00838400
.long 0x00758400
.long 0x007f8400
.long 0x42ca9100
.long 0x00000000
.long 0x00000000
.long 0x00000000
.long 0x00000000
.long 0x00000000
.long 0x00000000
.long 0x00000000
.long 0x00000000
.long 0x00388600
.long 0x001e8600
.long 0x00318600
.long 0x43d61150
.long 0x0100c900
.long 0x00e4c900
.long 0x00f2c900
.long 0x40f98100
.long 0x00000000
.long 0x00000000
.long 0x00000000
.long 0x00000000
.long 0x00000000
.long 0x00000002
.long 0x00000000
.long 0x00000000
.long 0x00b3d900
.long 0x0095d900
.long 0x00acd900
.long 0x421af158
.long 0x00838800
.long 0x00758800
.long 0x007f8800
.long 0x42ca9100
.long 0x00000000
.long 0x00000000
.long 0x00000000
.long 0x00000000
.long 0x00000000
.long 0x00000000
.long 0x00000000
.long 0x00000000
.long 0x00388a00
.long 0x001e8a00
.long 0x00318a00
.long 0x43d61150
.long 0x0100cd00
.long 0x00e4cd00
.long 0x00f2cd00
.long 0x40f98100
.long 0x00000000
.long 0x00000000
.long 0x00000000
.long 0x00000000
.long 0x00000000
.long 0x00000002
.long 0x00000000
.long 0x00000000
.long 0x00b3dd00
.long 0x0095dd00
.long 0x00acdd00
.long 0x421af158
.long 0x00838c00
.long 0x00758c00
.long 0x007f8c00
.long 0x42ca9100
.long 0x00000000
.long 0x00000000
.long 0x00000000
.long 0x00000000
.long 0x00000000
.long 0x00000000
.long 0x00000000
.long 0x00000000
.long 0x00388e00
.long 0x001e8e00
.long 0x00318e00
.long 0x43d61150
.long 0x0100c100
.long 0x00e4c100
.long 0x00f2c100
.long 0x40f98100
.long 0x00000000
.long 0x00000000
.long 0x00000000
.long 0x00000000
.long 0x00000000
.long 0x00000002
.long 0x00000000
.long 0x00000000
.long 0x00388100
.long 0x001e8100
.long 0x00298100
.long 0x43d61150
.long 0x004aa200
.long 0x0036a200
.long 0x0044a200
.long 0x41f10100
.long 0x00000000
.long 0x00000000
.long 0x00000000
.long 0x00000000
.long 0x00000000
.long 0x00000002
.long 0x00000000
.long 0x00000000
.long 0x00dfb400
.long 0x00bfb400
.long 0x00c1b400
.long 0x625cd150
.long 0x00c01300
.long 0x00b81300
.long 0x00ba1300
.long 0x40c59100
.long 0x00000000
.long 0x00000000
.long 0x00000000
.long 0x00000000
.long 0x00000000
.long 0x00000002
.long 0x00000000
.long 0x00000000
.long 0x00388500
.long 0x001e8500
.long 0x00298500
.long 0x43d61150
.long 0x004aa600
.long 0x0036a600
.long 0x0044a600
.long 0x41f10100
.long 0x00000000
.long 0x00000000
.long 0x00000000
.long 0x00000000
.long 0x00000000
.long 0x00000000
.long 0x00000000
.long 0x00000000
.long 0x00dfb800
.long 0x00bfb800
.long 0x00c1b800
.long 0x625cd150
.long 0x00c01700
.long 0x00b81700
.long 0x00ba1700
.long 0x40c59100
.long 0x00000000
.long 0x00000000
.long 0x00000000
.long 0x00000000
.long 0x00000000
.long 0x00000002
.long 0x00000000
.long 0x00000000
.long 0x00388900
.long 0x001e8900
.long 0x00298900
.long 0x43d61150
.long 0x004aaa00
.long 0x0036aa00
.long 0x0044aa00
.long 0x41f10100
.long 0x00000000
.long 0x00000000
.long 0x00000000
.long 0x00000000
.long 0x00000000
.long 0x00000000
.long 0x00000000
.long 0x00000000
.long 0x00dfbc00
.long 0x00bfbc00
.long 0x00c1bc00
.long 0x625cd150
.long 0x00c01b00
.long 0x00b81b00
.long 0x00ba1b00
.long 0x40c59100
.long 0x00000000
.long 0x00000000
.long 0x00000000
.long 0x00000000
.long 0x00000000
.long 0x00000002
.long 0x00000000
.long 0x00000000
.long 0x00388d00
.long 0x001e8d00
.long 0x00298d00
.long 0x43d61150
.long 0x004aae00
.long 0x0036ae00
.long 0x0044ae00
.long 0x41f10100
.long 0x00000000
.long 0x00000000
.long 0x00000000
.long 0x00000000
.long 0x00000000
.long 0x00000000
.long 0x00000000
.long 0x00000000
.long 0x00dfb000
.long 0x00bfb000
.long 0x00c1b000
.long 0x625cd150
.long 0x00c01f00
.long 0x00b81f00
.long 0x00ba1f00
.long 0x40c59100
.long 0x00000000
.long 0x00000000
.long 0x00000000
.long 0x00000000
.long 0x00000000
.long 0x00000002
.long 0x00000000
.long 0x00000000
.long 0x00388100
.long 0x001e8100
.long 0x00318100
.long 0x43d61150
.long 0x001ed300
.long 0x000ad300
.long 0x0018d300
.long 0x40b1a100
.long 0x00000000
.long 0x00000000
.long 0x00000000
.long 0x00000000
.long 0x00000000
.long 0x00000002
.long 0x00000000
.long 0x00000000
.long 0x00dfb500
.long 0x00bfb500
.long 0x00c1b500
.long 0x625cd150
.long 0x00b8d400
.long 0x00b2d400
.long 0x00b4d400
.long 0x41833100
.long 0x00000000
.long 0x00000000
.long 0x00000000
.long 0x00000000
.long 0x00000000
.long 0x00000002
.long 0x00000000
.long 0x00000000
.long 0x00388500
.long 0x001e8500
.long 0x00318500
.long 0x43d61150
.long 0x001ed700
.long 0x000ad700
.long 0x0018d700
.long 0x40b1a100
.long 0x00000000
.long 0x00000000
.long 0x00000000
.long 0x00000000
.long 0x00000000
.long 0x00000000
.long 0x00000000
.long 0x00000000
.long 0x00dfb900
.long 0x00bfb900
.long 0x00c1b900
.long 0x625cd150
.long 0x00b8d800
.long 0x00b2d800
.long 0x00b4d800
.long 0x41833100
.long 0x00000000
.long 0x00000000
.long 0x00000000
.long 0x00000000
.long 0x00000000
.long 0x00000002
.long 0x00000000
.long 0x00000000
.long 0x00388900
.long 0x001e8900
.long 0x00318900
.long 0x43d61150
.long 0x001edb00
.long 0x000adb00
.long 0x0018db00
.long 0x40b1a100
.long 0x00000000
.long 0x00000000
.long 0x00000000
.long 0x00000000
.long 0x00000000
.long 0x00000000
.long 0x00000000
.long 0x00000000
.long 0x00dfbd00
.long 0x00bfbd00
.long 0x00c1bd00
.long 0x625cd150
.long 0x00b8dc00
.long 0x00b2dc00
.long 0x00b4dc00
.long 0x41833100
.long 0x00000000
.long 0x00000000
.long 0x00000000
.long 0x00000000
.long 0x00000000
.long 0x00000002
.long 0x00000000
.long 0x00000000
.long 0x00388d00
.long 0x001e8d00
.long 0x00318d00
.long 0x43d61150
.long 0x001edf00
.long 0x000adf00
.long 0x0018df00
.long 0x40b1a100
.long 0x00000000
.long 0x00000000
.long 0x00000000
.long 0x00000000
.long 0x00000000
.long 0x00000000
.long 0x00000000
.long 0x00000000
.long 0x00dfb100
.long 0x00bfb100
.long 0x00c1b100
.long 0x625cd150
.long 0x00b8d000
.long 0x00b2d000
.long 0x00b4d000
.long 0x41833100
.long 0x00000000
.long 0x00000000
.long 0x00000000
.long 0x00000000
.long 0x00000000
.long 0x00000002
.long 0x00000000
.long 0x00000000
.long 0x0061b000
.long 0x0049b000
.long 0x004bb000
.long 0x61953150
.long 0x000c0000
.long 0xfffe0000
.long 0x00080000
.long 0x426ac100
.long 0x00000000
.long 0x00000000
.long 0x00000000
.long 0x00000000
.long 0x00000000
.long 0x00000002
.long 0x00000000
.long 0x00000000
.long 0x0061b200
.long 0x0049b200
.long 0x0057b200
.long 0x61953150
.long 0x00838300
.long 0x00758300
.long 0x00778300
.long 0x42ca9100
.long 0x00000000
.long 0x00000000
.long 0x00000000
.long 0x00000000
.long 0x00000000
.long 0x00000001
.long 0x00000000
.long 0x00000000
.long 0x0061b400
.long 0x0049b400
.long 0x004bb400
.long 0x61953150
.long 0x000c0400
.long 0xfffe0400
.long 0x00080400
.long 0x426ac100
.long 0x00000000
.long 0x00000000
.long 0x00000000
.long 0x00000000
.long 0x00000000
.long 0x00000000
.long 0x00000000
.long 0x00000000
.long 0x0061b600
.long 0x0049b600
.long 0x0057b600
.long 0x61953150
.long 0x00838700
.long 0x00758700
.long 0x00778700
.long 0x42ca9100
.long 0x00000000
.long 0x00000000
.long 0x00000000
.long 0x00000000
.long 0x00000000
.long 0x00000001
.long 0x00000000
.long 0x00000000
.long 0x0061b800
.long 0x0049b800
.long 0x004bb800
.long 0x61953150
.long 0x000c0800
.long 0xfffe0800
.long 0x00080800
.long 0x426ac100
.long 0x00000000
.long 0x00000000
.long 0x00000000
.long 0x00000000
.long 0x00000000
.long 0x00000000
.long 0x00000000
.long 0x00000000
.long 0x0061ba00
.long 0x0049ba00
.long 0x0057ba00
.long 0x61953150
.long 0x00838b00
.long 0x00758b00
.long 0x00778b00
.long 0x42ca9100
.long 0x00000000
.long 0x00000000
.long 0x00000000
.long 0x00000000
.long 0x00000000
.long 0x00000001
.long 0x00000000
.long 0x00000000
.long 0x0061bc00
.long 0x0049bc00
.long 0x004bbc00
.long 0x61953150
.long 0x000c0c00
.long 0xfffe0c00
.long 0x00080c00
.long 0x426ac100
.long 0x00000000
.long 0x00000000
.long 0x00000000
.long 0x00000000
.long 0x00000000
.long 0x00000000
.long 0x00000000
.long 0x00000000
.long 0x0061be00
.long 0x0049be00
.long 0x0057be00
.long 0x61953150
.long 0x00838f00
.long 0x00758f00
.long 0x00778f00
.long 0x42ca9100
.long 0x00000000
.long 0x00000000
.long 0x00000000
.long 0x00000000
.long 0x00000000
.long 0x00000001
.long 0x00000000
.long 0x00000000
.long 0x0061b100
.long 0x0049b100
.long 0x004bb100
.long 0x61953150
.long 0x000c0000
.long 0xfffe0000
.long 0x00000000
.long 0x426ac100
.long 0x00000000
.long 0x00000000
.long 0x00000000
.long 0x00000000
.long 0x00000000
.long 0x00000002
.long 0x00000000
.long 0x00000000
.long 0x0076f400
.long 0x0060f400
.long 0x006df400
.long 0x52f28150
.long 0x010e5300
.long 0x01005300
.long 0x010a5300
.long 0x416b4100
.long 0x00000000
.long 0x00000000
.long 0x00000000
.long 0x00000000
.long 0x00000000
.long 0x00000000
.long 0x00000000
.long 0x00000000
.long 0x0061b500
.long 0x0049b500
.long 0x004bb500
.long 0x61953150
.long 0x000c0400
.long 0xfffe0400
.long 0x00000400
.long 0x426ac100
.long 0x00000000
.long 0x00000000
.long 0x00000000
.long 0x00000000
.long 0x00000000
.long 0x00000000
.long 0x00000000
.long 0x00000000
.long 0x0076f800
.long 0x0060f800
.long 0x006df800
.long 0x52f28150
.long 0x010e5700
.long 0x01005700
.long 0x010a5700
.long 0x416b4100
.long 0x00000000
.long 0x00000000
.long 0x00000000
.long 0x00000000
.long 0x00000000
.long 0x00000000
.long 0x00000000
.long 0x00000000
.long 0x0061b900
.long 0x0049b900
.long 0x004bb900
.long 0x61953150
.long 0x000c0800
.long 0xfffe0800
.long 0x00000800
.long 0x426ac100
.long 0x00000000
.long 0x00000000
.long 0x00000000
.long 0x00000000
.long 0x00000000
.long 0x00000000
.long 0x00000000
.long 0x00000000
.long 0x0076fc00
.long 0x0060fc00
.long 0x006dfc00
.long 0x52f28150
.long 0x010e5b00
.long 0x01005b00
.long 0x010a5b00
.long 0x416b4100
.long 0x00000000
.long 0x00000000
.long 0x00000000
.long 0x00000000
.long 0x00000000
.long 0x00000000
.long 0x00000000
.long 0x00000000
.long 0x0061bd00
.long 0x0049bd00
.long 0x004bbd00
.long 0x61953150
.long 0x000c0c00
.long 0xfffe0c00
.long 0x00000c00
.long 0x426ac100
.long 0x00000000
.long 0x00000000
.long 0x00000000
.long 0x00000000
.long 0x00000000
.long 0x00000000
.long 0x00000000
.long 0x00000000
.long 0x0076f000
.long 0x0060f000
.long 0x006df000
.long 0x52f28150
.long 0x010e5f00
.long 0x01005f00
.long 0x010a5f00
.long 0x416b4100
.long 0x00000000
.long 0x00000000
.long 0x00000000
.long 0x00000000
.long 0x00000000
.long 0x00000000
.long 0x00000000
.long 0x00000000
.long 0x0061b000
.long 0x0049b000
.long 0x0057b000
.long 0x61953150
.long 0x010e5100
.long 0x01005100
.long 0x010a5100
.long 0x416b4100
.long 0x00000000
.long 0x00000000
.long 0x00000000
.long 0x00000000
.long 0x00000000
.long 0x00000004
.long 0x00000000
.long 0x00000000
.long 0x0076f400
.long 0x0060f400
.long 0x0062f400
.long 0x5af28150
.long 0x004aa400
.long 0x0036a400
.long 0x0044a400
.long 0x41f10100
.long 0x00000000
.long 0x00000000
.long 0x00000000
.long 0x00000000
.long 0x00000000
.long 0x00000002
.long 0x00000000
.long 0x00000000
.long 0x0061b400
.long 0x0049b400
.long 0x0057b400
.long 0x61953150
.long 0x010e5500
.long 0x01005500
.long 0x010a5500
.long 0x416b4100
.long 0x00000000
.long 0x00000000
.long 0x00000000
.long 0x00000000
.long 0x00000000
.long 0x00000002
.long 0x00000000
.long 0x00000000
.long 0x0076f800
.long 0x0060f800
.long 0x0062f800
.long 0x5af28150
.long 0x004aa800
.long 0x0036a800
.long 0x0044a800
.long 0x41f10100
.long 0x00000000
.long 0x00000000
.long 0x00000000
.long 0x00000000
.long 0x00000000
.long 0x00000002
.long 0x00000000
.long 0x00000000
.long 0x0061b800
.long 0x0049b800
.long 0x0057b800
.long 0x61953150
.long 0x010e5900
.long 0x01005900
.long 0x010a5900
.long 0x416b4100
.long 0x00000000
.long 0x00000000
.long 0x00000000
.long 0x00000000
.long 0x00000000
.long 0x00000002
.long 0x00000000
.long 0x00000000
.long 0x0076fc00
.long 0x0060fc00
.long 0x0062fc00
.long 0x5af28150
.long 0x004aac00
.long 0x0036ac00
.long 0x0044ac00
.long 0x41f10100
.long 0x00000000
.long 0x00000000
.long 0x00000000
.long 0x00000000
.long 0x00000000
.long 0x00000002
.long 0x00000000
.long 0x00000000
.long 0x0061bc00
.long 0x0049bc00
.long 0x0057bc00
.long 0x61953150
.long 0x010e5d00
.long 0x01005d00
.long 0x010a5d00
.long 0x416b4100
.long 0x00000000
.long 0x00000000
.long 0x00000000
.long 0x00000000
.long 0x00000000
.long 0x00000002
.long 0x00000000
.long 0x00000000
.long 0x0076f000
.long 0x0060f000
.long 0x0062f000
.long 0x5af28150
.long 0x004aa000
.long 0x0036a000
.long 0x0044a000
.long 0x41f10100
.long 0x00000000
.long 0x00000000
.long 0x00000000
.long 0x00000000
.long 0x00000000
.long 0x00000002
.long 0x00000000
.long 0x00000000
.long 0x0061b100
.long 0x0049b100
.long 0x0057b100
.long 0x61953150
.long 0x010e5100
.long 0x01005100
.long 0x01025100
.long 0x416b4100
.long 0x00000000
.long 0x00000000
.long 0x00000000
.long 0x00000000
.long 0x00000000
.long 0x00000002
.long 0x00000000
.long 0x00000000
.long 0x0076f500
.long 0x0060f500
.long 0x0062f500
.long 0x5af28150
.long 0x000c0200
.long 0xfffe0200
.long 0x00080200
.long 0x426ac100
.long 0x00000000
.long 0x00000000
.long 0x00000000
.long 0x00000000
.long 0x00000000
.long 0x00000000
.long 0x00000000
.long 0x00000000
.long 0x0061b500
.long 0x0049b500
.long 0x0057b500
.long 0x61953150
.long 0x010e5500
.long 0x01005500
.long 0x01025500
.long 0x416b4100
.long 0x00000000
.long 0x00000000
.long 0x00000000
.long 0x00000000
.long 0x00000000
.long 0x00000000
.long 0x00000000
.long 0x00000000
.long 0x0076f900
.long 0x0060f900
.long 0x0062f900
.long 0x5af28150
.long 0x000c0600
.long 0xfffe0600
.long 0x00080600
.long 0x426ac100
.long 0x00000000
.long 0x00000000
.long 0x00000000
.long 0x00000000
.long 0x00000000
.long 0x00000000
.long 0x00000000
.long 0x00000000
.long 0x0061b900
.long 0x0049b900
.long 0x0057b900
.long 0x61953150
.long 0x010e5900
.long 0x01005900
.long 0x01025900
.long 0x416b4100
.long 0x00000000
.long 0x00000000
.long 0x00000000
.long 0x00000000
.long 0x00000000
.long 0x00000000
.long 0x00000000
.long 0x00000000
.long 0x0076fd00
.long 0x0060fd00
.long 0x0062fd00
.long 0x5af28150
.long 0x000c0a00
.long 0xfffe0a00
.long 0x00080a00
.long 0x426ac100
.long 0x00000000
.long 0x00000000
.long 0x00000000
.long 0x00000000
.long 0x00000000
.long 0x00000000
.long 0x00000000
.long 0x00000000
.long 0x0061bd00
.long 0x0049bd00
.long 0x0057bd00
.long 0x61953150
.long 0x010e5d00
.long 0x01005d00
.long 0x01025d00
.long 0x416b4100
.long 0x00000000
.long 0x00000000
.long 0x00000000
.long 0x00000000
.long 0x00000000
.long 0x00000000
.long 0x00000000
.long 0x00000000
.long 0x0076f100
.long 0x0060f100
.long 0x0062f100
.long 0x5af28150
.long 0x000c0e00
.long 0xfffe0e00
.long 0x00080e00
.long 0x426ac100
.long 0x00000000
.long 0x00000000
.long 0x00000000
.long 0x00000000
.long 0x00000000
.long 0x00000000
.long 0x00000000
.long 0x00000000
.long 0x0100c300
.long 0x00e4c300
.long 0x00f2c300
.long 0x40f98170
.long 0x00962300
.long 0x00822300
.long 0x00842300
.long 0x60b1a100
.long 0x00000000
.long 0x00000000
.long 0x00000000
.long 0x00000000
.long 0x00000000
.long 0x00000004
.long 0x00000000
.long 0x00000000
.long 0x00962500
.long 0x00822500
.long 0x00902500
.long 0x40b1a150
.long 0x00b3d300
.long 0x0095d300
.long 0x00acd300
.long 0x421af100
.long 0x00000000
.long 0x00000000
.long 0x00000000
.long 0x00000000
.long 0x00000000
.long 0x00000004
.long 0x00000000
.long 0x00000000
.long 0x0100c700
.long 0x00e4c700
.long 0x00f2c700
.long 0x40f98170
.long 0x00962700
.long 0x00822700
.long 0x00842700
.long 0x60b1a100
.long 0x00000000
.long 0x00000000
.long 0x00000000
.long 0x00000000
.long 0x00000000
.long 0x00000003
.long 0x00000000
.long 0x00000000
.long 0x00962900
.long 0x00822900
.long 0x00902900
.long 0x40b1a150
.long 0x00b3d700
.long 0x0095d700
.long 0x00acd700
.long 0x421af100
.long 0x00000000
.long 0x00000000
.long 0x00000000
.long 0x00000000
.long 0x00000000
.long 0x00000004
.long 0x00000000
.long 0x00000000
.long 0x0100cb00
.long 0x00e4cb00
.long 0x00f2cb00
.long 0x40f98170
.long 0x00962b00
.long 0x00822b00
.long 0x00842b00
.long 0x60b1a100
.long 0x00000000
.long 0x00000000
.long 0x00000000
.long 0x00000000
.long 0x00000000
.long 0x00000003
.long 0x00000000
.long 0x00000000
.long 0x00962d00
.long 0x00822d00
.long 0x00902d00
.long 0x40b1a150
.long 0x00b3db00
.long 0x0095db00
.long 0x00acdb00
.long 0x421af100
.long 0x00000000
.long 0x00000000
.long 0x00000000
.long 0x00000000
.long 0x00000000
.long 0x00000004
.long 0x00000000
.long 0x00000000
.long 0x0100cf00
.long 0x00e4cf00
.long 0x00f2cf00
.long 0x40f98170
.long 0x00962f00
.long 0x00822f00
.long 0x00842f00
.long 0x60b1a100
.long 0x00000000
.long 0x00000000
.long 0x00000000
.long 0x00000000
.long 0x00000000
.long 0x00000003
.long 0x00000000
.long 0x00000000
.long 0x00962100
.long 0x00822100
.long 0x00902100
.long 0x40b1a150
.long 0x00b3df00
.long 0x0095df00
.long 0x00acdf00
.long 0x421af100
.long 0x00000000
.long 0x00000000
.long 0x00000000
.long 0x00000000
.long 0x00000000
.long 0x00000004
.long 0x00000000
.long 0x00000000
.long 0x00388000
.long 0x001e8000
.long 0x00318000
.long 0x43d61168
.long 0x001ed200
.long 0x000ad200
.long 0x000cd200
.long 0x60b1a100
.long 0x00000000
.long 0x00000000
.long 0x00000000
.long 0x00000000
.long 0x00000000
.long 0x00000004
.long 0x00000000
.long 0x00000000
.long 0x00dfb500
.long 0x00bfb500
.long 0x00d8b500
.long 0x425cd150
.long 0x000c0200
.long 0xfffe0200
.long 0x00000200
.long 0x426ac100
.long 0x00000000
.long 0x00000000
.long 0x00000000
.long 0x00000000
.long 0x00000000
.long 0x00000001
.long 0x00000000
.long 0x00000000
.long 0x00388400
.long 0x001e8400
.long 0x00318400
.long 0x43d61168
.long 0x001ed600
.long 0x000ad600
.long 0x000cd600
.long 0x60b1a100
.long 0x00000000
.long 0x00000000
.long 0x00000000
.long 0x00000000
.long 0x00000000
.long 0x00000002
.long 0x00000000
.long 0x00000000
.long 0x00dfb900
.long 0x00bfb900
.long 0x00d8b900
.long 0x425cd150
.long 0x000c0600
.long 0xfffe0600
.long 0x00000600
.long 0x426ac100
.long 0x00000000
.long 0x00000000
.long 0x00000000
.long 0x00000000
.long 0x00000000
.long 0x00000001
.long 0x00000000
.long 0x00000000
.long 0x00388800
.long 0x001e8800
.long 0x00318800
.long 0x43d61168
.long 0x001eda00
.long 0x000ada00
.long 0x000cda00
.long 0x60b1a100
.long 0x00000000
.long 0x00000000
.long 0x00000000
.long 0x00000000
.long 0x00000000
.long 0x00000002
.long 0x00000000
.long 0x00000000
.long 0x00dfbd00
.long 0x00bfbd00
.long 0x00d8bd00
.long 0x425cd150
.long 0x000c0a00
.long 0xfffe0a00
.long 0x00000a00
.long 0x426ac100
.long 0x00000000
.long 0x00000000
.long 0x00000000
.long 0x00000000
.long 0x00000000
.long 0x00000001
.long 0x00000000
.long 0x00000000
.long 0x00388c00
.long 0x001e8c00
.long 0x00318c00
.long 0x43d61168
.long 0x001ede00
.long 0x000ade00
.long 0x000cde00
.long 0x60b1a100
.long 0x00000000
.long 0x00000000
.long 0x00000000
.long 0x00000000
.long 0x00000000
.long 0x00000002
.long 0x00000000
.long 0x00000000
.long 0x00dfb100
.long 0x00bfb100
.long 0x00d8b100
.long 0x425cd150
.long 0x000c0e00
.long 0xfffe0e00
.long 0x00000e00
.long 0x426ac100
.long 0x00000000
.long 0x00000000
.long 0x00000000
.long 0x00000000
.long 0x00000000
.long 0x00000001
.long 0x00000000
.long 0x00000000
.long 0x00dfb200
.long 0x00bfb200
.long 0x00d8b200
.long 0x425cd150
.long 0x00962200
.long 0x00822200
.long 0x00902200
.long 0x40b1a100
.long 0x00000000
.long 0x00000000
.long 0x00000000
.long 0x00000000
.long 0x00000000
.long 0x00000002
.long 0x00000000
.long 0x00000000
.long 0x00dfb400
.long 0x00bfb400
.long 0x00d8b400
.long 0x425cd150
.long 0x00962400
.long 0x00822400
.long 0x00902400
.long 0x40b1a100
.long 0x00000000
.long 0x00000000
.long 0x00000000
.long 0x00000000
.long 0x00000000
.long 0x00000001
.long 0x00000000
.long 0x00000000
.long 0x00dfb600
.long 0x00bfb600
.long 0x00d8b600
.long 0x425cd150
.long 0x00962600
.long 0x00822600
.long 0x00902600
.long 0x40b1a100
.long 0x00000000
.long 0x00000000
.long 0x00000000
.long 0x00000000
.long 0x00000000
.long 0x00000000
.long 0x00000000
.long 0x00000000
.long 0x00dfb800
.long 0x00bfb800
.long 0x00d8b800
.long 0x425cd150
.long 0x00962800
.long 0x00822800
.long 0x00902800
.long 0x40b1a100
.long 0x00000000
.long 0x00000000
.long 0x00000000
.long 0x00000000
.long 0x00000000
.long 0x00000001
.long 0x00000000
.long 0x00000000
.long 0x00dfba00
.long 0x00bfba00
.long 0x00d8ba00
.long 0x425cd150
.long 0x00962a00
.long 0x00822a00
.long 0x00902a00
.long 0x40b1a100
.long 0x00000000
.long 0x00000000
.long 0x00000000
.long 0x00000000
.long 0x00000000
.long 0x00000000
.long 0x00000000
.long 0x00000000
.long 0x00dfbc00
.long 0x00bfbc00
.long 0x00d8bc00
.long 0x425cd150
.long 0x00962c00
.long 0x00822c00
.long 0x00902c00
.long 0x40b1a100
.long 0x00000000
.long 0x00000000
.long 0x00000000
.long 0x00000000
.long 0x00000000
.long 0x00000001
.long 0x00000000
.long 0x00000000
.long 0x00dfbe00
.long 0x00bfbe00
.long 0x00d8be00
.long 0x425cd150
.long 0x00962e00
.long 0x00822e00
.long 0x00902e00
.long 0x40b1a100
.long 0x00000000
.long 0x00000000
.long 0x00000000
.long 0x00000000
.long 0x00000000
.long 0x00000000
.long 0x00000000
.long 0x00000000
.long 0x00dfb000
.long 0x00bfb000
.long 0x00d8b000
.long 0x425cd150
.long 0x00962000
.long 0x00822000
.long 0x00902000
.long 0x40b1a100
.long 0x00000000
.long 0x00000000
.long 0x00000000
.long 0x00000000
.long 0x00000000
.long 0x00000001
.long 0x00000000
.long 0x00000000
.long 0x00dfb300
.long 0x00bfb300
.long 0x00d8b300
.long 0x425cd160
.long 0x00838000
.long 0x00758000
.long 0x00778000
.long 0x42ca9100
.long 0x00000000
.long 0x00000000
.long 0x00000000
.long 0x00000000
.long 0x00000000
.long 0x00000002
.long 0x00000000
.long 0x00000000
.long 0x00b3d200
.long 0x0095d200
.long 0x00acd200
.long 0x421af150
.long 0x004aa500
.long 0x0036a500
.long 0x0044a500
.long 0x41f10100
.long 0x00000000
.long 0x00000000
.long 0x00000000
.long 0x00000000
.long 0x00000000
.long 0x00000001
.long 0x00000000
.long 0x00000000
.long 0x00dfb700
.long 0x00bfb700
.long 0x00d8b700
.long 0x425cd160
.long 0x00838400
.long 0x00758400
.long 0x00778400
.long 0x42ca9100
.long 0x00000000
.long 0x00000000
.long 0x00000000
.long 0x00000000
.long 0x00000000
.long 0x00000000
.long 0x00000000
.long 0x00000000
.long 0x00b3d600
.long 0x0095d600
.long 0x00acd600
.long 0x421af150
.long 0x004aa900
.long 0x0036a900
.long 0x0044a900
.long 0x41f10100
.long 0x00000000
.long 0x00000000
.long 0x00000000
.long 0x00000000
.long 0x00000000
.long 0x00000001
.long 0x00000000
.long 0x00000000
.long 0x00dfbb00
.long 0x00bfbb00
.long 0x00d8bb00
.long 0x425cd160
.long 0x00838800
.long 0x00758800
.long 0x00778800
.long 0x42ca9100
.long 0x00000000
.long 0x00000000
.long 0x00000000
.long 0x00000000
.long 0x00000000
.long 0x00000000
.long 0x00000000
.long 0x00000000
.long 0x00b3da00
.long 0x0095da00
.long 0x00acda00
.long 0x421af150
.long 0x004aad00
.long 0x0036ad00
.long 0x0044ad00
.long 0x41f10100
.long 0x00000000
.long 0x00000000
.long 0x00000000
.long 0x00000000
.long 0x00000000
.long 0x00000001
.long 0x00000000
.long 0x00000000
.long 0x00dfbf00
.long 0x00bfbf00
.long 0x00d8bf00
.long 0x425cd160
.long 0x00838c00
.long 0x00758c00
.long 0x00778c00
.long 0x42ca9100
.long 0x00000000
.long 0x00000000
.long 0x00000000
.long 0x00000000
.long 0x00000000
.long 0x00000000
.long 0x00000000
.long 0x00000000
.long 0x00b3de00
.long 0x0095de00
.long 0x00acde00
.long 0x421af150
.long 0x004aa100
.long 0x0036a100
.long 0x0044a100
.long 0x41f10100
.long 0x00000000
.long 0x00000000
.long 0x00000000
.long 0x00000000
.long 0x00000000
.long 0x00000001
.long 0x00000000
.long 0x00000000
.long 0x0076f200
.long 0x0060f200
.long 0x0062f200
.long 0x5af28150
.long 0x00838100
.long 0x00758100
.long 0x007f8100
.long 0x42ca9100
.long 0x00000000
.long 0x00000000
.long 0x00000000
.long 0x00000000
.long 0x00000000
.long 0x00000002
.long 0x00000000
.long 0x00000000
.long 0x0076f500
.long 0x0060f500
.long 0x006df500
.long 0x52f28150
.long 0x00838300
.long 0x00758300
.long 0x007f8300
.long 0x42ca9100
.long 0x00000000
.long 0x00000000
.long 0x00000000
.long 0x00000000
.long 0x00000000
.long 0x00000000
.long 0x00000000
.long 0x00000000
.long 0x0076f600
.long 0x0060f600
.long 0x0062f600
.long 0x5af28150
.long 0x00838500
.long 0x00758500
.long 0x007f8500
.long 0x42ca9100
.long 0x00000000
.long 0x00000000
.long 0x00000000
.long 0x00000000
.long 0x00000000
.long 0x00000000
.long 0x00000000
.long 0x00000000
.long 0x0076f900
.long 0x0060f900
.long 0x006df900
.long 0x52f28150
.long 0x00838700
.long 0x00758700
.long 0x007f8700
.long 0x42ca9100
.long 0x00000000
.long 0x00000000
.long 0x00000000
.long 0x00000000
.long 0x00000000
.long 0x00000000
.long 0x00000000
.long 0x00000000
.long 0x0076fa00
.long 0x0060fa00
.long 0x0062fa00
.long 0x5af28150
.long 0x00838900
.long 0x00758900
.long 0x007f8900
.long 0x42ca9100
.long 0x00000000
.long 0x00000000
.long 0x00000000
.long 0x00000000
.long 0x00000000
.long 0x00000000
.long 0x00000000
.long 0x00000000
.long 0x0076fd00
.long 0x0060fd00
.long 0x006dfd00
.long 0x52f28150
.long 0x00838b00
.long 0x00758b00
.long 0x007f8b00
.long 0x42ca9100
.long 0x00000000
.long 0x00000000
.long 0x00000000
.long 0x00000000
.long 0x00000000
.long 0x00000000
.long 0x00000000
.long 0x00000000
.long 0x0076fe00
.long 0x0060fe00
.long 0x0062fe00
.long 0x5af28150
.long 0x00838d00
.long 0x00758d00
.long 0x007f8d00
.long 0x42ca9100
.long 0x00000000
.long 0x00000000
.long 0x00000000
.long 0x00000000
.long 0x00000000
.long 0x00000000
.long 0x00000000
.long 0x00000000
.long 0x0076f100
.long 0x0060f100
.long 0x006df100
.long 0x52f28150
.long 0x00838f00
.long 0x00758f00
.long 0x007f8f00
.long 0x42ca9100
.long 0x00000000
.long 0x00000000
.long 0x00000000
.long 0x00000000
.long 0x00000000
.long 0x00000000
.long 0x00000000
.long 0x00000000
.long 0x0076f300
.long 0x0060f300
.long 0x0062f300
.long 0x5af28150
.long 0x000c0100
.long 0xfffe0100
.long 0x00080100
.long 0x426ac100
.long 0x00000000
.long 0x00000000
.long 0x00000000
.long 0x00000000
.long 0x00000000
.long 0x00000002
.long 0x00000000
.long 0x00000000
.long 0x0061b300
.long 0x0049b300
.long 0x0057b300
.long 0x61953150
.long 0x001ed400
.long 0x000ad400
.long 0x0018d400
.long 0x40b1a100
.long 0x00000000
.long 0x00000000
.long 0x00000000
.long 0x00000000
.long 0x00000000
.long 0x00000003
.long 0x00000000
.long 0x00000000
.long 0x0076f700
.long 0x0060f700
.long 0x0062f700
.long 0x5af28150
.long 0x000c0500
.long 0xfffe0500
.long 0x00080500
.long 0x426ac100
.long 0x00000000
.long 0x00000000
.long 0x00000000
.long 0x00000000
.long 0x00000000
.long 0x00000000
.long 0x00000000
.long 0x00000000
.long 0x0061b700
.long 0x0049b700
.long 0x0057b700
.long 0x61953150
.long 0x001ed800
.long 0x000ad800
.long 0x0018d800
.long 0x40b1a100
.long 0x00000000
.long 0x00000000
.long 0x00000000
.long 0x00000000
.long 0x00000000
.long 0x00000003
.long 0x00000000
.long 0x00000000
.long 0x0076fb00
.long 0x0060fb00
.long 0x0062fb00
.long 0x5af28150
.long 0x000c0900
.long 0xfffe0900
.long 0x00080900
.long 0x426ac100
.long 0x00000000
.long 0x00000000
.long 0x00000000
.long 0x00000000
.long 0x00000000
.long 0x00000000
.long 0x00000000
.long 0x00000000
.long 0x0061bb00
.long 0x0049bb00
.long 0x0057bb00
.long 0x61953150
.long 0x001edc00
.long 0x000adc00
.long 0x0018dc00
.long 0x40b1a100
.long 0x00000000
.long 0x00000000
.long 0x00000000
.long 0x00000000
.long 0x00000000
.long 0x00000003
.long 0x00000000
.long 0x00000000
.long 0x0076ff00
.long 0x0060ff00
.long 0x0062ff00
.long 0x5af28150
.long 0x000c0d00
.long 0xfffe0d00
.long 0x00080d00
.long 0x426ac100
.long 0x00000000
.long 0x00000000
.long 0x00000000
.long 0x00000000
.long 0x00000000
.long 0x00000000
.long 0x00000000
.long 0x00000000
.long 0x0061bf00
.long 0x0049bf00
.long 0x0057bf00
.long 0x61953150
.long 0x001ed000
.long 0x000ad000
.long 0x0018d000
.long 0x40b1a100
.long 0x00000000
.long 0x00000000
.long 0x00000000
.long 0x00000000
.long 0x00000000
.long 0x00000003
.long 0x00000000
.long 0x00000000
.long 0x0076f200
.long 0x0060f200
.long 0x006df200
.long 0x52f28150
.long 0x004aa300
.long 0x0036a300
.long 0x0044a300
.long 0x41f10100
.long 0x00000000
.long 0x00000000
.long 0x00000000
.long 0x00000000
.long 0x00000000
.long 0x00000002
.long 0x00000000
.long 0x00000000
.long 0x001ed500
.long 0x000ad500
.long 0x000cd500
.long 0x60b1a150
.long 0x001ed500
.long 0x000ad500
.long 0x0018d500
.long 0x40b1a100
.long 0x00000000
.long 0x00000000
.long 0x00000000
.long 0x00000000
.long 0x00000000
.long 0x00000004
.long 0x00000000
.long 0x00000000
.long 0x0076f600
.long 0x0060f600
.long 0x006df600
.long 0x52f28150
.long 0x004aa700
.long 0x0036a700
.long 0x0044a700
.long 0x41f10100
.long 0x00000000
.long 0x00000000
.long 0x00000000
.long 0x00000000
.long 0x00000000
.long 0x00000000
.long 0x00000000
.long 0x00000000
.long 0x001ed900
.long 0x000ad900
.long 0x000cd900
.long 0x60b1a150
.long 0x001ed900
.long 0x000ad900
.long 0x0018d900
.long 0x40b1a100
.long 0x00000000
.long 0x00000000
.long 0x00000000
.long 0x00000000
.long 0x00000000
.long 0x00000004
.long 0x00000000
.long 0x00000000
.long 0x0076fa00
.long 0x0060fa00
.long 0x006dfa00
.long 0x52f28150
.long 0x004aab00
.long 0x0036ab00
.long 0x0044ab00
.long 0x41f10100
.long 0x00000000
.long 0x00000000
.long 0x00000000
.long 0x00000000
.long 0x00000000
.long 0x00000000
.long 0x00000000
.long 0x00000000
.long 0x001edd00
.long 0x000add00
.long 0x000cdd00
.long 0x60b1a150
.long 0x001edd00
.long 0x000add00
.long 0x0018dd00
.long 0x40b1a100
.long 0x00000000
.long 0x00000000
.long 0x00000000
.long 0x00000000
.long 0x00000000
.long 0x00000004
.long 0x00000000
.long 0x00000000
.long 0x0076fe00
.long 0x0060fe00
.long 0x006dfe00
.long 0x52f28150
.long 0x004aaf00
.long 0x0036af00
.long 0x0044af00
.long 0x41f10100
.long 0x00000000
.long 0x00000000
.long 0x00000000
.long 0x00000000
.long 0x00000000
.long 0x00000000
.long 0x00000000
.long 0x00000000
.long 0x001ed100
.long 0x000ad100
.long 0x000cd100
.long 0x60b1a150
.long 0x001ed100
.long 0x000ad100
.long 0x0018d100
.long 0x40b1a100
.long 0x00000000
.long 0x00000000
.long 0x00000000
.long 0x00000000
.long 0x00000000
.long 0x00000004
.long 0x00000000
.long 0x00000000
.long 0x0076f300
.long 0x0060f300
.long 0x006df300
.long 0x52f28150
.long 0x001ed200
.long 0x000ad200
.long 0x0018d200
.long 0x40b1a100
.long 0x00000000
.long 0x00000000
.long 0x00000000
.long 0x00000000
.long 0x00000000
.long 0x00000002
.long 0x00000000
.long 0x00000000
.long 0x00962500
.long 0x00822500
.long 0x00842500
.long 0x60b1a150
.long 0x00388300
.long 0x001e8300
.long 0x00318300
.long 0x43d61100
.long 0x00000000
.long 0x00000000
.long 0x00000000
.long 0x00000000
.long 0x00000000
.long 0x00000004
.long 0x00000000
.long 0x00000000
.long 0x0076f700
.long 0x0060f700
.long 0x006df700
.long 0x52f28150
.long 0x001ed600
.long 0x000ad600
.long 0x0018d600
.long 0x40b1a100
.long 0x00000000
.long 0x00000000
.long 0x00000000
.long 0x00000000
.long 0x00000000
.long 0x00000000
.long 0x00000000
.long 0x00000000
.long 0x00962900
.long 0x00822900
.long 0x00842900
.long 0x60b1a150
.long 0x00388700
.long 0x001e8700
.long 0x00318700
.long 0x43d61100
.long 0x00000000
.long 0x00000000
.long 0x00000000
.long 0x00000000
.long 0x00000000
.long 0x00000004
.long 0x00000000
.long 0x00000000
.long 0x0076fb00
.long 0x0060fb00
.long 0x006dfb00
.long 0x52f28150
.long 0x001eda00
.long 0x000ada00
.long 0x0018da00
.long 0x40b1a100
.long 0x00000000
.long 0x00000000
.long 0x00000000
.long 0x00000000
.long 0x00000000
.long 0x00000000
.long 0x00000000
.long 0x00000000
.long 0x00962d00
.long 0x00822d00
.long 0x00842d00
.long 0x60b1a150
.long 0x00388b00
.long 0x001e8b00
.long 0x00318b00
.long 0x43d61100
.long 0x00000000
.long 0x00000000
.long 0x00000000
.long 0x00000000
.long 0x00000000
.long 0x00000004
.long 0x00000000
.long 0x00000000
.long 0x0076ff00
.long 0x0060ff00
.long 0x006dff00
.long 0x52f28150
.long 0x001ede00
.long 0x000ade00
.long 0x0018de00
.long 0x40b1a100
.long 0x00000000
.long 0x00000000
.long 0x00000000
.long 0x00000000
.long 0x00000000
.long 0x00000000
.long 0x00000000
.long 0x00000000
.long 0x00962100
.long 0x00822100
.long 0x00842100
.long 0x60b1a150
.long 0x00388f00
.long 0x001e8f00
.long 0x00318f00
.long 0x43d61100
.long 0x00000000
.long 0x00000000
.long 0x00000000
.long 0x00000000
.long 0x00000000
.long 0x00000004
.long 0x00000000
.long 0x00000000
.long 0x00dfb200
.long 0x00bfb200
.long 0x00c1b200
.long 0x625cd150
.long 0x0115a200
.long 0x010da200
.long 0x010fa200
.long 0x41455100
.long 0x00000000
.long 0x00000000
.long 0x00000000
.long 0x00000000
.long 0x00000000
.long 0x00000003
.long 0x00000000
.long 0x00000000
.long 0x00dfb400
.long 0x00bfb400
.long 0x00cdb400
.long 0x5a5cd150
.long 0x00c01200
.long 0x00b81200
.long 0x00ba1200
.long 0x40c59100
.long 0x00000000
.long 0x00000000
.long 0x00000000
.long 0x00000000
.long 0x00000000
.long 0x00000002
.long 0x00000000
.long 0x00000000
.long 0x00dfb600
.long 0x00bfb600
.long 0x00c1b600
.long 0x625cd150
.long 0x0115a600
.long 0x010da600
.long 0x010fa600
.long 0x41455100
.long 0x00000000
.long 0x00000000
.long 0x00000000
.long 0x00000000
.long 0x00000000
.long 0x00000001
.long 0x00000000
.long 0x00000000
.long 0x00dfb800
.long 0x00bfb800
.long 0x00cdb800
.long 0x5a5cd150
.long 0x00c01600
.long 0x00b81600
.long 0x00ba1600
.long 0x40c59100
.long 0x00000000
.long 0x00000000
.long 0x00000000
.long 0x00000000
.long 0x00000000
.long 0x00000002
.long 0x00000000
.long 0x00000000
.long 0x00dfba00
.long 0x00bfba00
.long 0x00c1ba00
.long 0x625cd150
.long 0x0115aa00
.long 0x010daa00
.long 0x010faa00
.long 0x41455100
.long 0x00000000
.long 0x00000000
.long 0x00000000
.long 0x00000000
.long 0x00000000
.long 0x00000001
.long 0x00000000
.long 0x00000000
.long 0x00dfbc00
.long 0x00bfbc00
.long 0x00cdbc00
.long 0x5a5cd150
.long 0x00c01a00
.long 0x00b81a00
.long 0x00ba1a00
.long 0x40c59100
.long 0x00000000
.long 0x00000000
.long 0x00000000
.long 0x00000000
.long 0x00000000
.long 0x00000002
.long 0x00000000
.long 0x00000000
.long 0x00dfbe00
.long 0x00bfbe00
.long 0x00c1be00
.long 0x625cd150
.long 0x0115ae00
.long 0x010dae00
.long 0x010fae00
.long 0x41455100
.long 0x00000000
.long 0x00000000
.long 0x00000000
.long 0x00000000
.long 0x00000000
.long 0x00000001
.long 0x00000000
.long 0x00000000
.long 0x00dfb000
.long 0x00bfb000
.long 0x00cdb000
.long 0x5a5cd150
.long 0x00c01e00
.long 0x00b81e00
.long 0x00ba1e00
.long 0x40c59100
.long 0x00000000
.long 0x00000000
.long 0x00000000
.long 0x00000000
.long 0x00000000
.long 0x00000002
.long 0x00000000
.long 0x00000000
.long 0x00dfb300
.long 0x00bfb300
.long 0x00c1b300
.long 0x625cd160
.long 0x0115a300
.long 0x010da300
.long 0x010fa300
.long 0x41455100
.long 0x00000000
.long 0x00000000
.long 0x00000000
.long 0x00000000
.long 0x00000000
.long 0x00000004
.long 0x00000000
.long 0x00000000
.long 0x00dfb500
.long 0x00bfb500
.long 0x00cdb500
.long 0x5a5cd150
.long 0x00b8d500
.long 0x00b2d500
.long 0x00b4d500
.long 0x41833100
.long 0x00000000
.long 0x00000000
.long 0x00000000
.long 0x00000000
.long 0x00000000
.long 0x00000003
.long 0x00000000
.long 0x00000000
.long 0x00dfb700
.long 0x00bfb700
.long 0x00c1b700
.long 0x625cd160
.long 0x0115a700
.long 0x010da700
.long 0x010fa700
.long 0x41455100
.long 0x00000000
.long 0x00000000
.long 0x00000000
.long 0x00000000
.long 0x00000000
.long 0x00000002
.long 0x00000000
.long 0x00000000
.long 0x00dfb900
.long 0x00bfb900
.long 0x00cdb900
.long 0x5a5cd150
.long 0x00b8d900
.long 0x00b2d900
.long 0x00b4d900
.long 0x41833100
.long 0x00000000
.long 0x00000000
.long 0x00000000
.long 0x00000000
.long 0x00000000
.long 0x00000003
.long 0x00000000
.long 0x00000000
.long 0x00dfbb00
.long 0x00bfbb00
.long 0x00c1bb00
.long 0x625cd160
.long 0x0115ab00
.long 0x010dab00
.long 0x010fab00
.long 0x41455100
.long 0x00000000
.long 0x00000000
.long 0x00000000
.long 0x00000000
.long 0x00000000
.long 0x00000002
.long 0x00000000
.long 0x00000000
.long 0x00dfbd00
.long 0x00bfbd00
.long 0x00cdbd00
.long 0x5a5cd150
.long 0x00b8dd00
.long 0x00b2dd00
.long 0x00b4dd00
.long 0x41833100
.long 0x00000000
.long 0x00000000
.long 0x00000000
.long 0x00000000
.long 0x00000000
.long 0x00000003
.long 0x00000000
.long 0x00000000
.long 0x00dfbf00
.long 0x00bfbf00
.long 0x00c1bf00
.long 0x625cd160
.long 0x0115af00
.long 0x010daf00
.long 0x010faf00
.long 0x41455100
.long 0x00000000
.long 0x00000000
.long 0x00000000
.long 0x00000000
.long 0x00000000
.long 0x00000002
.long 0x00000000
.long 0x00000000
.long 0x00dfb100
.long 0x00bfb100
.long 0x00cdb100
.long 0x5a5cd150
.long 0x00b8d100
.long 0x00b2d100
.long 0x00b4d100
.long 0x41833100
.long 0x00000000
.long 0x00000000
.long 0x00000000
.long 0x00000000
.long 0x00000000
.long 0x00000003
.long 0x00000000
.long 0x00000000
.long 0x00dfb200
.long 0x00bfb200
.long 0x00cdb200
.long 0x5a5cd150
.long 0x00e69000
.long 0x00de9000
.long 0x00e09000
.long 0x43a42100
.long 0x00000000
.long 0x00000000
.long 0x00000000
.long 0x00000000
.long 0x00000000
.long 0x00000002
.long 0x00000000
.long 0x00000000
.long 0x00b3d200
.long 0x0095d200
.long 0x0097d200
.long 0x5a1af150
.long 0x0115a400
.long 0x010da400
.long 0x010fa400
.long 0x41455100
.long 0x00000000
.long 0x00000000
.long 0x00000000
.long 0x00000000
.long 0x00000000
.long 0x00000002
.long 0x00000000
.long 0x00000000
.long 0x00dfb600
.long 0x00bfb600
.long 0x00cdb600
.long 0x5a5cd150
.long 0x00e69400
.long 0x00de9400
.long 0x00e09400
.long 0x43a42100
.long 0x00000000
.long 0x00000000
.long 0x00000000
.long 0x00000000
.long 0x00000000
.long 0x00000000
.long 0x00000000
.long 0x00000000
.long 0x00b3d600
.long 0x0095d600
.long 0x0097d600
.long 0x5a1af150
.long 0x0115a800
.long 0x010da800
.long 0x010fa800
.long 0x41455100
.long 0x00000000
.long 0x00000000
.long 0x00000000
.long 0x00000000
.long 0x00000000
.long 0x00000002
.long 0x00000000
.long 0x00000000
.long 0x00dfba00
.long 0x00bfba00
.long 0x00cdba00
.long 0x5a5cd150
.long 0x00e69800
.long 0x00de9800
.long 0x00e09800
.long 0x43a42100
.long 0x00000000
.long 0x00000000
.long 0x00000000
.long 0x00000000
.long 0x00000000
.long 0x00000000
.long 0x00000000
.long 0x00000000
.long 0x00b3da00
.long 0x0095da00
.long 0x0097da00
.long 0x5a1af150
.long 0x0115ac00
.long 0x010dac00
.long 0x010fac00
.long 0x41455100
.long 0x00000000
.long 0x00000000
.long 0x00000000
.long 0x00000000
.long 0x00000000
.long 0x00000002
.long 0x00000000
.long 0x00000000
.long 0x00dfbe00
.long 0x00bfbe00
.long 0x00cdbe00
.long 0x5a5cd150
.long 0x00e69c00
.long 0x00de9c00
.long 0x00e09c00
.long 0x43a42100
.long 0x00000000
.long 0x00000000
.long 0x00000000
.long 0x00000000
.long 0x00000000
.long 0x00000000
.long 0x00000000
.long 0x00000000
.long 0x00b3de00
.long 0x0095de00
.long 0x0097de00
.long 0x5a1af150
.long 0x0115a000
.long 0x010da000
.long 0x010fa000
.long 0x41455100
.long 0x00000000
.long 0x00000000
.long 0x00000000
.long 0x00000000
.long 0x00000000
.long 0x00000002
.long 0x00000000
.long 0x00000000
.long 0x00dfb300
.long 0x00bfb300
.long 0x00cdb300
.long 0x5a5cd150
.long 0x00b8d200
.long 0x00b2d200
.long 0x00b4d200
.long 0x41833100
.long 0x00000000
.long 0x00000000
.long 0x00000000
.long 0x00000000
.long 0x00000000
.long 0x00000002
.long 0x00000000
.long 0x00000000
.long 0x00b3d300
.long 0x0095d300
.long 0x0097d300
.long 0x5a1af150
.long 0x00e69300
.long 0x00de9300
.long 0x00e09300
.long 0x43a42100
.long 0x00000000
.long 0x00000000
.long 0x00000000
.long 0x00000000
.long 0x00000000
.long 0x00000002
.long 0x00000000
.long 0x00000000
.long 0x00dfb700
.long 0x00bfb700
.long 0x00cdb700
.long 0x5a5cd150
.long 0x00b8d600
.long 0x00b2d600
.long 0x00b4d600
.long 0x41833100
.long 0x00000000
.long 0x00000000
.long 0x00000000
.long 0x00000000
.long 0x00000000
.long 0x00000000
.long 0x00000000
.long 0x00000000
.long 0x00b3d700
.long 0x0095d700
.long 0x0097d700
.long 0x5a1af150
.long 0x00e69700
.long 0x00de9700
.long 0x00e09700
.long 0x43a42100
.long 0x00000000
.long 0x00000000
.long 0x00000000
.long 0x00000000
.long 0x00000000
.long 0x00000002
.long 0x00000000
.long 0x00000000
.long 0x00dfbb00
.long 0x00bfbb00
.long 0x00cdbb00
.long 0x5a5cd150
.long 0x00b8da00
.long 0x00b2da00
.long 0x00b4da00
.long 0x41833100
.long 0x00000000
.long 0x00000000
.long 0x00000000
.long 0x00000000
.long 0x00000000
.long 0x00000000
.long 0x00000000
.long 0x00000000
.long 0x00b3db00
.long 0x0095db00
.long 0x0097db00
.long 0x5a1af150
.long 0x00e69b00
.long 0x00de9b00
.long 0x00e09b00
.long 0x43a42100
.long 0x00000000
.long 0x00000000
.long 0x00000000
.long 0x00000000
.long 0x00000000
.long 0x00000002
.long 0x00000000
.long 0x00000000
.long 0x00dfbf00
.long 0x00bfbf00
.long 0x00cdbf00
.long 0x5a5cd150
.long 0x00b8de00
.long 0x00b2de00
.long 0x00b4de00
.long 0x41833100
.long 0x00000000
.long 0x00000000
.long 0x00000000
.long 0x00000000
.long 0x00000000
.long 0x00000000
.long 0x00000000
.long 0x00000000
.long 0x00b3df00
.long 0x0095df00
.long 0x0097df00
.long 0x5a1af150
.long 0x00e69f00
.long 0x00de9f00
.long 0x00e09f00
.long 0x43a42100
.long 0x00000000
.long 0x00000000
.long 0x00000000
.long 0x00000000
.long 0x00000000
.long 0x00000002
.long 0x00000000
.long 0x00000000
.size L_table, 16384
.section .rodata,"a"
.p2align 6
.amdhsa_kernel standalone__varlen_attn_packed__ragged_kernel
  .amdhsa_next_free_vgpr 384
  .amdhsa_next_free_sgpr 102
  .amdhsa_accum_offset 256
  .amdhsa_group_segment_fixed_size 0
  .amdhsa_kernarg_size 56
  .amdhsa_user_sgpr_count 2
  .amdhsa_user_sgpr_kernarg_segment_ptr 1
  .amdhsa_system_sgpr_workgroup_id_x 1
.end_amdhsa_kernel
```
